```python
import torch

def _softmax(x, axis=-1):
    return torch.softmax(x, dim=axis)
def _gelu(x):
    return torch.nn.functional.gelu(x, approximate="tanh")
def _silu(x):
    return torch.nn.functional.silu(x)
def _sigmoid(x):
    return torch.sigmoid(x)
def _layernorm(x, axis=-1, eps=1e-5):
    m = x.mean(dim=axis, keepdim=True)
    v = x.var(dim=axis, keepdim=True, unbiased=False)
    return (x - m) / torch.sqrt(v + eps)
def _scatter_add(tgt, idx, src, axis=0):
    return tgt.clone().index_add_(axis, idx, src)
def _segment_sum(src, seg, n):
    out = torch.zeros((n,) + src.shape[1:], dtype=src.dtype)
    return out.index_add_(0, seg, src)
def _pad(x, pw):
    flat = tuple(v for pair in reversed(pw) for v in pair)
    return torch.nn.functional.pad(x, flat)

kernel_name = 'interleave_layers__mha_block_cached__dense_activation_gelu__decode'

def setup_inputs():

    _w = (lambda a: (lambda t: t.to(torch.bfloat16) if t.is_floating_point() else t)(torch.as_tensor(a)))
    def _A_setup():
        B, Sq, D = 1, 1, 512
        H, Sk, Dh = 32, 4096, 128
        return {
            "x": _w((lambda *s: torch.randn(*s, dtype=torch.bfloat16) * 0.05)(B, Sq, D)),
            "k_cache": _w((lambda *s: torch.randn(*s, dtype=torch.bfloat16) * 0.8)(B, H, Sk, Dh)),
            "v_cache": _w((lambda *s: torch.randn(*s, dtype=torch.bfloat16) * 1.6)(B, H, Sk, Dh)),
            "wq": _w((lambda *s: torch.randn(*s, dtype=torch.bfloat16) * 0.8)(D, H * Dh) * (D ** -0.5)),
            "wo": _w((lambda *s: torch.randn(*s, dtype=torch.bfloat16) * 1.6)(H * Dh, D) * ((H * Dh) ** -0.5)),
        }
    _A_in = _A_setup()

    def _B_setup():
        B, S, D, F = 1, 1, 512, 1376
        return {
            "x": _w((lambda *s: torch.randn(*s, dtype=torch.bfloat16) * 0.05)(B, S, D)),
            "w1": _w((lambda *s: torch.randn(*s, dtype=torch.bfloat16) * 0.4)(D, F) * (D ** -0.5)),
            "b1": _w((lambda *s: torch.randn(*s, dtype=torch.bfloat16) * 0.4)(F) * 0.01),
            "w2": _w((lambda *s: torch.randn(*s, dtype=torch.bfloat16) * 0.4)(F, D) * (F ** -0.5)),
            "b2": _w((lambda *s: torch.randn(*s, dtype=torch.bfloat16) * 0.4)(D) * 0.01),
        }
    _B_in = _B_setup()

    return {
        "A_x": _A_in["x"],
        "A_k_cache": _A_in["k_cache"],
        "A_v_cache": _A_in["v_cache"],
        "A_wq": _A_in["wq"],
        "A_wo": _A_in["wo"],
        "B_x": _B_in["x"],
        "B_w1": _B_in["w1"],
        "B_b1": _B_in["b1"],
        "B_w2": _B_in["w2"],
        "B_b2": _B_in["b2"],
    }

def reference(A_x, A_k_cache, A_v_cache, A_wq, A_wo, B_x, B_w1, B_b1, B_w2, B_b2):
    def _A_ref(x, k_cache, v_cache, wq, wo):
        B, Sq, D = x.shape
        H, Dh = 32, 128
        q = (lambda x, *d: x.permute(*d))((x @ wq).reshape(B, Sq, H, Dh), 0, 2, 1, 3)
        scores = torch.einsum("bhqd,bhkd->bhqk", q, k_cache) * (Dh ** -0.5)
        p = _softmax(scores, axis=-1)
        o = torch.einsum("bhqk,bhkd->bhqd", p, v_cache)
        return (lambda x, *d: x.permute(*d))(o, 0, 2, 1, 3).reshape(B, Sq, H * Dh) @ wo

    def _B_ref(x, w1, b1, w2, b2):
        h = torch.einsum("bsd,df->bsf", x, w1) + b1
        h = _gelu(h)
        return torch.einsum("bsf,fd->bsd", h, w2) + b2

    x = A_x
    x = x + _A_ref(_layernorm(x, axis=-1), A_k_cache, A_v_cache, A_wq, A_wo)
    x = x + _B_ref(_layernorm(x, axis=-1), B_w1, B_b1, B_w2, B_b2)
    x = x + _A_ref(_layernorm(x, axis=-1), A_k_cache, A_v_cache, A_wq, A_wo)
    x = x + _B_ref(_layernorm(x, axis=-1), B_w1, B_b1, B_w2, B_b2)
    return x
```

```asm
; @launch grid=(256,1,1) block=(256,1,1) lds=159744
.amdgcn_target "amdgcn-amd-amdhsa--gfx950"
.text
.globl interleave_layers__mha_block_cached__dense_activation_gelu__decode_kernel
.p2align 8
.type interleave_layers__mha_block_cached__dense_activation_gelu__decode_kernel,@function
interleave_layers__mha_block_cached__dense_activation_gelu__decode_kernel:
    s_cmp_ge_u32 s2, 256
    s_cbranch_scc1 L_end
    s_load_dwordx16 s[16:31], s[0:1], 0
    s_load_dwordx8 s[32:39], s[0:1], 64
    s_load_dwordx2 s[40:41], s[0:1], 96
    v_lshrrev_b32 v24, 6, v0
    v_and_b32 v0, 63, v0
    v_readfirstlane_b32 s3, v24
    s_and_b32 s4, s2, 7
    s_lshr_b32 s5, s2, 3
    s_and_b32 s85, s5, 3
    s_lshl_b32 s6, s4, 2
    s_add_u32 s6, s6, s85
    s_lshr_b32 s7, s5, 2
    s_lshl_b32 s71, s6, 20
    s_lshl_b32 s85, s7, 17
    s_add_u32 s71, s71, s85
    s_lshl_b32 s89, s3, 15
    s_lshl_b32 s85, s3, 13
    s_add_u32 s71, s71, s85
    v_lshrrev_b32 v32, 4, v0
    v_and_b32 v33, 15, v0
    v_lshlrev_b32 v1, 4, v0
    s_getpc_b64 s[58:59]
L_pc:
    s_lshl_b32 s85, s5, 2
    s_add_u32 s85, s85, s3
    s_and_b32 s85, s85, 31
    s_lshl_b32 s85, s85, 9
    v_lshlrev_b32 v45, 3, v0
    v_add_u32 v45, s85, v45
    v_min_u32 v45, L_codeend-L_pc-8, v45
    global_load_dwordx2 v[248:249], v45, s[58:59]
    v_lshrrev_b32 v34, 3, v0
    v_and_b32 v36, 0x70, v1
    v_and_b32 v37, 16, v0
    v_lshlrev_b32 v37, 1, v37
    v_xor_b32 v36, v36, v37
    v_lshl_add_u32 v44, v34, 13, v36
    v_xor_b32 v45, 64, v44
    v_xor_b32 v37, v33, v32
    v_lshlrev_b32 v37, 4, v37
    v_lshl_add_u32 v88, v32, 8, v37
    v_xor_b32 v89, 64, v88
    v_xor_b32 v90, 128, v88
    v_xor_b32 v91, 192, v88
    s_and_b32 s85, s7, 3
    s_lshl_b32 s85, s85, 2
    s_add_u32 s85, s85, s3
    s_lshl_b32 s88, s85, 18
    s_lshl_b32 s85, s6, 8
    s_add_u32 s88, s88, s85
    s_lshr_b32 s85, s7, 2
    s_lshl_b32 s85, s85, 7
    s_add_u32 s88, s88, s85
    s_lshl_b32 s86, s3, 12
    s_lshl_b32 s85, s5, 2
    s_add_u32 s85, s85, s3
    s_mul_i32 s85, s85, 544
    s_mul_i32 s87, s4, 0x14000
    s_add_u32 s87, s87, 0x20000
    s_add_u32 s85, s85, s87
    v_add_u32 v46, s85, v1
    s_lshl_b32 s85, s2, 9
    v_add_u32 v47, s85, v1
    v_lshrrev_b32 v43, 5, v0
    v_mul_u32_u24 v43, 0xbfe00, v43
    v_add_u32 v47, v47, v43
    v_mov_b32 v72, -1
    v_mov_b32 v73, -1
    v_mov_b32 v74, -1
    v_mov_b32 v75, -1
    s_waitcnt lgkmcnt(0)
    s_mov_b32 s38, s87
    s_cmp_lg_u32 s3, 3
    s_cbranch_scc1 L_noxr
    global_store_dwordx4 v47, v[72:75], s[40:41] sc1
    s_mov_b32 exec_hi, -1
L_noxr:
    s_mov_b32 s52, s22
    s_and_b32 s53, s23, 0xffff
    s_mov_b32 s54, 0x400000
    s_mov_b32 s55, 0x20000
    s_add_u32 m0, s86, 131072
    s_nop 0
    buffer_load_dwordx4 v44, s[52:55], s88 offen nt lds
    s_add_u32 m0, s86, 132096
    s_add_u32 s88, s88, 65536
    buffer_load_dwordx4 v45, s[52:55], s88 offen nt lds
    s_add_u32 m0, s86, 133120
    s_add_u32 s88, s88, 65536
    buffer_load_dwordx4 v44, s[52:55], s88 offen nt lds
    s_add_u32 m0, s86, 134144
    s_add_u32 s88, s88, 65536
    buffer_load_dwordx4 v45, s[52:55], s88 offen nt lds
    global_load_dwordx4 v[108:111], v1, s[16:17]
    s_mov_b32 exec_hi, 3
    global_store_dwordx4 v46, v[72:75], s[40:41]
    s_mov_b32 exec_hi, -1
    s_mov_b32 s44, s18
    s_and_b32 s45, s19, 0xffff
    s_mov_b32 s46, 0x2000000
    s_mov_b32 s47, 0x20000
    s_add_u32 s58, s40, 0x190000
    s_addc_u32 s59, s41, 0
    s_load_dword s56, s[58:59], 0
    s_add_u32 m0, s89, 0
    s_add_u32 s91, s71, 0
    buffer_load_dwordx4 v88, s[44:47], s91 offen offset:0 nt lds
    buffer_load_dwordx4 v89, s[44:47], s91 offen offset:1024 nt lds
    buffer_load_dwordx4 v90, s[44:47], s91 offen offset:2048 nt lds
    buffer_load_dwordx4 v91, s[44:47], s91 offen offset:3072 nt lds
    s_mov_b32 s48, s20
    s_and_b32 s49, s21, 0xffff
    s_mov_b32 s50, 0x2000000
    s_mov_b32 s51, 0x20000
    s_mov_b32 s8, s40
    s_and_b32 s9, s41, 0xffff
    s_mov_b32 s10, 0x200000
    s_mov_b32 s11, 0x20000
    v_lshl_add_u32 v122, v34, 10, v36
    v_xor_b32 v123, 64, v122
    v_lshrrev_b32 v35, 5, v0
    v_and_b32 v36, 1, v0
    v_lshlrev_b32 v36, 4, v36
    v_lshl_add_u32 v38, v35, 5, v36
    v_lshlrev_b32 v125, 2, v0
    v_lshlrev_b32 v10, 1, v0
    v_lshl_add_u32 v92, v33, 8, v37
    v_add_u32 v92, s89, v92
    v_xor_b32 v93, 64, v92
    v_xor_b32 v94, 128, v92
    v_xor_b32 v95, 192, v92
    v_lshlrev_b32 v36, 4, v33
    v_lshlrev_b32 v37, 5, v32
    v_xor_b32 v36, v36, v37
    v_lshl_add_u32 v112, v32, 8, v36
    v_xor_b32 v113, 0x80, v112
    v_bfe_u32 v36, v0, 2, 2
    v_lshl_add_u32 v37, v32, 3, v36
    v_bfe_u32 v39, v0, 2, 3
    v_and_b32 v34, 3, v0
    v_lshlrev_b32 v34, 3, v34
    v_lshl_add_u32 v114, v39, 5, v34
    v_lshl_add_u32 v114, v37, 8, v114
    v_add_u32 v114, s89, v114
    v_xor_b32 v115, 32, v114
    v_xor_b32 v116, 64, v114
    v_xor_b32 v117, 96, v114
    v_xor_b32 v118, 128, v114
    v_xor_b32 v119, 160, v114
    v_xor_b32 v120, 192, v114
    v_xor_b32 v121, 224, v114
    v_bfe_u32 v39, v0, 3, 2
    v_lshl_add_u32 v127, v39, 5, v34
    v_lshl_add_u32 v127, v37, 7, v127
    s_lshl_b32 s87, s3, 11
    s_add_u32 s87, s87, 0x24000
    v_add_u32 v2, s87, v1
    v_lshlrev_b32 v27, 4, v32
    v_and_b32 v28, 3, v0
    v_cmp_eq_u32 vcc, 1, v28
    v_mov_b32 v29, 1024
    s_nop 0
    v_cndmask_b32 v29, 0, v29, vcc
    v_add3_u32 v3, v29, s87, v27
    v_add_u32 v12, 0x26040, v27
    v_lshlrev_b32 v13, 3, v32
    v_add_u32 v13, 0x26080, v13
    s_and_b32 s85, s7, 3
    s_lshl_b32 s85, s85, 8
    v_add_u32 v5, s85, v3
    v_mul_u32_u24 v9, 320, v28
    v_add_u32 v9, v9, v27
    v_lshlrev_b32 v4, 3, v0
    v_add_u32 v4, s89, v4
    v_add_u32 v6, s87, v10
    s_lshl_b32 s88, s3, 9
    s_add_u32 s88, s88, 0x26800
    v_lshlrev_b32 v7, 2, v0
    v_add_u32 v7, s88, v7
    s_lshl_b32 s88, s3, 2
    s_add_u32 s86, s88, 0x26000
    v_mov_b32 v8, s86
    v_lshlrev_b32 v11, 2, v33
    v_lshl_add_u32 v11, v32, 11, v11
    s_mov_b32 s72, 0xffff0000
    s_mov_b32 s73, 0
    s_mov_b32 s74, 0
    s_mov_b32 s75, 0xffff
    s_mov_b32 s76, 0
    s_mov_b32 s77, 0xffff0000
    s_mov_b32 s78, 0
    s_mov_b32 s79, -1
    s_mov_b32 s80, 0
    s_mov_b32 s84, 0
    s_mov_b32 s82, 0x3e0293ee
    s_mov_b32 s83, 0x3f803f80
    s_add_u32 s67, s38, 0x8000
    s_and_b32 s86, s5, 3
    s_lshl_b32 s62, s86, 11
    s_add_u32 s62, s62, s38
    s_lshl_b32 s63, s86, 7
    s_add_u32 s63, s63, s38
    s_add_u32 s63, s63, 0x9000
    s_lshl_b32 s70, s86, 10
    s_add_u32 s70, s70, s38
    s_add_u32 s70, s70, 0x10000
    s_add_u32 s68, s70, s85
    s_lshr_b32 s85, s7, 2
    s_lshl_b32 s85, s85, 7
    s_add_u32 s68, s68, s85
    s_lshl_b32 s85, s3, 5
    s_add_u32 s68, s68, s85
    s_lshl_b32 s64, s7, 13
    s_lshl_b32 s85, s6, 8
    s_add_u32 s64, s64, s85
    s_lshl_b32 s85, s3, 6
    s_add_u32 s69, s64, s85
    s_add_u32 s69, s69, 0x10000
    s_add_u32 s90, s38, 0x2000
    v_mov_b32 v68, s83
    v_mov_b32 v69, s83
    v_mov_b32 v70, s83
    v_mov_b32 v71, s83
    ds_write_b128 v2, v[68:71] offset:1024
    s_add_u32 m0, s89, 4096
    s_add_u32 s91, s71, 4096
    buffer_load_dwordx4 v88, s[44:47], s91 offen offset:0 nt lds
    buffer_load_dwordx4 v89, s[44:47], s91 offen offset:1024 nt lds
    buffer_load_dwordx4 v90, s[44:47], s91 offen offset:2048 nt lds
    buffer_load_dwordx4 v91, s[44:47], s91 offen offset:3072 nt lds
    s_add_u32 m0, s89, 8192
    s_add_u32 s91, s71, 32768
    buffer_load_dwordx4 v88, s[44:47], s91 offen offset:0 nt lds
    buffer_load_dwordx4 v89, s[44:47], s91 offen offset:1024 nt lds
    buffer_load_dwordx4 v90, s[44:47], s91 offen offset:2048 nt lds
    buffer_load_dwordx4 v91, s[44:47], s91 offen offset:3072 nt lds
    v_mov_b32 v40, v32
    v_mov_b32 v41, v33
    v_mov_b32 v42, v35
    s_lshl_b32 s57, s6, 11
    s_add_u32 s57, s57, 0x180000
    s_lshl_b32 s85, s3, 11
    s_add_u32 s85, s85, 0x24000
    v_lshlrev_b32 v126, 3, v0
    v_lshl_add_u32 v126, v35, 6, v126
    v_add_u32 v126, s85, v126
    v_mul_u32_u24 v21, 320, v32
    v_lshl_add_u32 v21, v33, 3, v21
    v_add_u32 v21, 0x1f000, v21
    v_and_b32 v23, 7, v0
    v_mul_u32_u24 v23, 160, v23
    v_lshl_add_u32 v23, v32, 4, v23
    v_add_u32 v23, 0x1f000, v23
    v_add_u32 v9, s85, v9
    s_sub_u32 s93, s68, s70
    s_lshl_b32 s93, s93, 1
    s_add_u32 s39, s93, s57
    s_waitcnt vmcnt(12) lgkmcnt(0)
    s_lshr_b32 s56, s56, 3
    s_mul_i32 s56, s56, 0x9e3779b1
    s_add_u32 s56, s56, 0x7f4a7c15
    s_lshl_b32 s56, s56, 3
    s_getreg_b32 s85, hwreg(HW_REG_XCC_ID, 0, 3)
    s_or_b32 s56, s56, s85
    s_barrier
    s_lshl_b32 s43, s4, 7
    s_add_u32 s43, s43, 0x191000
    s_lshl_b32 s85, s5, 2
    v_mov_b32 v98, s85
    v_and_b32 v99, 0x7c, v125
    v_mov_b32 v97, s56
    s_cmp_lg_u32 s3, 3
    s_cbranch_scc1 L_noent
    s_mov_b64 exec, 1
    buffer_store_dword v97, v98, s[8:11], s43 offen
    s_mov_b64 exec, -1
L_noent:
    s_lshl_b32 s85, s3, 5
    s_add_u32 s85, s85, 0x20000
    v_xor_b32 v30, s85, v127
    ds_read_b64_tr_b16 a[216:217], v30 offset:0
    ds_read_b64_tr_b16 a[218:219], v30 offset:512
    ds_read_b64_tr_b16 a[220:221], v30 offset:4096
    ds_read_b64_tr_b16 a[222:223], v30 offset:4608
    ds_read_b64_tr_b16 a[224:225], v30 offset:8192
    ds_read_b64_tr_b16 a[226:227], v30 offset:8704
    ds_read_b64_tr_b16 a[228:229], v30 offset:12288
    ds_read_b64_tr_b16 a[230:231], v30 offset:12800
    s_add_u32 m0, s89, 12288
    s_add_u32 s91, s71, 36864
    buffer_load_dwordx4 v88, s[44:47], s91 offen offset:0 nt lds
    buffer_load_dwordx4 v89, s[44:47], s91 offen offset:1024 nt lds
    buffer_load_dwordx4 v90, s[44:47], s91 offen offset:2048 nt lds
    buffer_load_dwordx4 v91, s[44:47], s91 offen offset:3072 nt lds
    s_waitcnt lgkmcnt(0)
    ds_write_b128 v2, v[108:111]
    ds_read_b128 v[64:67], v5 offset:0
    ds_read_b128 v[68:71], v5 offset:64
    ds_read_b128 v[72:75], v5 offset:128
    ds_read_b128 v[76:79], v5 offset:192
    v_dot2_f32_bf16 v25, v108, s83, 0
    v_dot2_f32_bf16 v26, v108, v108, 0
    v_dot2_f32_bf16 v25, v109, s83, v25
    v_dot2_f32_bf16 v26, v109, v109, v26
    v_dot2_f32_bf16 v25, v110, s83, v25
    v_dot2_f32_bf16 v26, v110, v110, v26
    v_dot2_f32_bf16 v25, v111, s83, v25
    v_dot2_f32_bf16 v26, v111, v111, v26
    v_mov_b32 v27, 0x3b000000
    s_nop 0
    v_add_f32_dpp v25, v25, v25 row_shr:1 row_mask:0xf bank_mask:0xf
    v_add_f32_dpp v26, v26, v26 row_shr:1 row_mask:0xf bank_mask:0xf
    s_nop 0
    v_add_f32_dpp v25, v25, v25 row_shr:2 row_mask:0xf bank_mask:0xf
    v_add_f32_dpp v26, v26, v26 row_shr:2 row_mask:0xf bank_mask:0xf
    s_nop 0
    v_add_f32_dpp v25, v25, v25 row_shr:4 row_mask:0xf bank_mask:0xf
    v_add_f32_dpp v26, v26, v26 row_shr:4 row_mask:0xf bank_mask:0xf
    s_waitcnt lgkmcnt(3)
    v_mfma_f32_16x16x32_bf16 v[32:35], v[64:67], a[216:219], 0
    v_add_f32_dpp v25, v25, v25 row_shr:8 row_mask:0xf bank_mask:0xf
    v_add_f32_dpp v26, v26, v26 row_shr:8 row_mask:0xf bank_mask:0xf
    s_waitcnt lgkmcnt(2)
    v_mfma_f32_16x16x32_bf16 v[32:35], v[68:71], a[220:223], v[32:35]
    v_add_f32_dpp v25, v25, v25 row_bcast:15 row_mask:0xa bank_mask:0xf
    v_add_f32_dpp v26, v26, v26 row_bcast:15 row_mask:0xa bank_mask:0xf
    s_waitcnt lgkmcnt(1)
    v_mfma_f32_16x16x32_bf16 v[32:35], v[72:75], a[224:227], v[32:35]
    v_add_f32_dpp v25, v25, v25 row_bcast:31 row_mask:0xc bank_mask:0xf
    v_add_f32_dpp v26, v26, v26 row_bcast:31 row_mask:0xc bank_mask:0xf
    s_waitcnt lgkmcnt(0)
    v_mfma_f32_16x16x32_bf16 v[32:35], v[76:79], a[228:231], v[32:35]
    v_readlane_b32 s85, v25, 63
    v_readlane_b32 s86, v26, 63
    s_nop 0
    v_mul_f32 v28, s85, v27
    v_mul_f32 v29, s86, v27
    v_fma_f32 v29, -v28, v28, v29
    v_max_f32 v29, 0, v29
    v_add_f32 v29, 0x3727c5ac, v29
    v_rsq_f32 v29, v29
    v_fma_f32 v24, -v28, v33, v32
    v_mul_f32 v24, v29, v24
    s_nop 1
    v_mov_b32_dpp v25, v24 quad_perm:[1,1,3,3] row_mask:0xf bank_mask:0xf
    v_cvt_pk_bf16_f32 v25, v24, v25
    v_min_u32 v25, -2, v25
    v_mov_b32 v96, v25
    s_mov_b64 exec, 0x5555
    buffer_store_dwordx2 v[96:97], v125, s[8:11], s39 offen
    s_mov_b64 exec, -1
    v_mov_b32 v32, v40
    v_mov_b32 v33, v41
    v_mov_b32 v35, v42
    s_add_u32 m0, s89, 16384
    s_add_u32 s91, s71, 65536
    buffer_load_dwordx4 v88, s[44:47], s91 offen offset:0 nt lds
    buffer_load_dwordx4 v89, s[44:47], s91 offen offset:1024 nt lds
    buffer_load_dwordx4 v90, s[44:47], s91 offen offset:2048 nt lds
    buffer_load_dwordx4 v91, s[44:47], s91 offen offset:3072 nt lds
    s_cmp_eq_u32 s3, 3
    s_cbranch_scc1 L_w3
    s_mov_b32 s12, s32
    s_and_b32 s13, s33, 0xffff
    s_mov_b32 s14, 0x158000
    s_mov_b32 s15, 0x20000
    v_and_b32 v24, 3, v0
    v_bfe_u32 v25, v0, 4, 1
    v_lshl_add_u32 v26, v25, 1, v35
    v_lshl_add_u32 v26, v24, 2, v26
    v_lshlrev_b32 v26, 1, v26
    s_lshl_b32 s85, s3, 5
    s_add_u32 s86, s85, 0x26040
    v_add_u32 v16, s86, v26
    s_mul_i32 s86, s6, 96
    s_add_u32 s86, s86, s85
    v_add_u32 v26, s86, v26
    v_min_u32 v26, 2750, v26
    global_load_ushort v14, v26, s[30:31]
    s_and_b32 s85, s5, 3
    s_mul_i32 s85, s85, 3
    s_add_u32 s85, s85, s3
    s_lshl_b32 s85, s85, 11
    s_add_u32 s90, s90, s85
    v_bfe_u32 v124, v0, 1, 4
    s_movk_i32 s85, 2752
    v_mul_lo_u32 v124, v124, s85
    v_add_u32 v124, v124, v38
    s_mul_i32 s43, s6, 49152
    s_lshl_b32 s85, s7, 7
    s_add_u32 s43, s43, s85
    s_add_u32 m0, s89, 20480
    s_add_u32 s91, s71, 69632
    buffer_load_dwordx4 v88, s[44:47], s91 offen offset:0 nt lds
    buffer_load_dwordx4 v89, s[44:47], s91 offen offset:1024 nt lds
    buffer_load_dwordx4 v90, s[44:47], s91 offen offset:2048 nt lds
    buffer_load_dwordx4 v91, s[44:47], s91 offen offset:3072 nt lds
    s_add_u32 m0, s89, 24576
    s_add_u32 s91, s71, 98304
    buffer_load_dwordx4 v88, s[44:47], s91 offen offset:0 nt lds
    buffer_load_dwordx4 v89, s[44:47], s91 offen offset:1024 nt lds
    buffer_load_dwordx4 v90, s[44:47], s91 offen offset:2048 nt lds
    buffer_load_dwordx4 v91, s[44:47], s91 offen offset:3072 nt lds
    s_add_u32 m0, s89, 28672
    s_add_u32 s91, s71, 102400
    buffer_load_dwordx4 v88, s[44:47], s91 offen offset:0 nt lds
    buffer_load_dwordx4 v89, s[44:47], s91 offen offset:1024 nt lds
    buffer_load_dwordx4 v90, s[44:47], s91 offen offset:2048 nt lds
    buffer_load_dwordx4 v91, s[44:47], s91 offen offset:3072 nt lds
    s_mov_b32 s52, s28
    s_and_b32 s53, s29, 0xffff
    s_mov_b32 s54, 0x158000
    s_mov_b32 s55, 0x20000
    s_mul_i32 s42, s5, 44032
    s_mul_i32 s85, s4, 384
    s_add_u32 s42, s42, s85
    s_lshl_b32 s85, s3, 7
    s_add_u32 s42, s42, s85
    s_waitcnt vmcnt(26) lgkmcnt(6)
    ds_read_b128 a[0:3], v92 offset:0
    ds_read_b128 a[4:7], v93 offset:0
    ds_read_b128 a[8:11], v94 offset:0
    ds_read_b128 a[12:15], v95 offset:0
    ds_read_b128 a[16:19], v92 offset:4096
    ds_read_b128 a[20:23], v93 offset:4096
    ds_read_b128 a[24:27], v94 offset:4096
    ds_read_b128 a[28:31], v95 offset:4096
    s_waitcnt vmcnt(18) lgkmcnt(6)
    ds_read_b128 a[32:35], v92 offset:8192
    ds_read_b128 a[36:39], v93 offset:8192
    ds_read_b128 a[40:43], v94 offset:8192
    ds_read_b128 a[44:47], v95 offset:8192
    ds_read_b128 a[48:51], v92 offset:12288
    ds_read_b128 a[52:55], v93 offset:12288
    ds_read_b128 a[56:59], v94 offset:12288
    ds_read_b128 a[60:63], v95 offset:12288
    s_waitcnt lgkmcnt(8)
    s_add_u32 m0, s89, 0
    s_add_u32 s92, s71, 0
    buffer_load_dwordx4 v112, s[48:51], s92 offen offset:0 nt lds
    buffer_load_dwordx4 v112, s[48:51], s92 offen offset:1024 nt lds
    buffer_load_dwordx4 v113, s[48:51], s92 offen offset:2048 nt lds
    buffer_load_dwordx4 v113, s[48:51], s92 offen offset:3072 nt lds
    s_add_u32 m0, s89, 4096
    s_add_u32 s92, s71, 4096
    buffer_load_dwordx4 v112, s[48:51], s92 offen offset:0 nt lds
    buffer_load_dwordx4 v112, s[48:51], s92 offen offset:1024 nt lds
    buffer_load_dwordx4 v113, s[48:51], s92 offen offset:2048 nt lds
    buffer_load_dwordx4 v113, s[48:51], s92 offen offset:3072 nt lds
    buffer_load_dwordx4 v[32:35], v1, s[8:11], s57 offen offset:0 sc1
    buffer_load_dwordx4 v[36:39], v1, s[8:11], s57 offen offset:1024 sc1
    s_waitcnt vmcnt(18) lgkmcnt(6)
    ds_read_b128 a[64:67], v92 offset:16384
    ds_read_b128 a[68:71], v93 offset:16384
    ds_read_b128 a[72:75], v94 offset:16384
    ds_read_b128 a[76:79], v95 offset:16384
    ds_read_b128 a[80:83], v92 offset:20480
    ds_read_b128 a[84:87], v93 offset:20480
    ds_read_b128 a[88:91], v94 offset:20480
    ds_read_b128 a[92:95], v95 offset:20480
    s_waitcnt lgkmcnt(8)
    s_add_u32 m0, s89, 8192
    s_add_u32 s92, s71, 32768
    buffer_load_dwordx4 v112, s[48:51], s92 offen offset:0 nt lds
    buffer_load_dwordx4 v112, s[48:51], s92 offen offset:1024 nt lds
    buffer_load_dwordx4 v113, s[48:51], s92 offen offset:2048 nt lds
    buffer_load_dwordx4 v113, s[48:51], s92 offen offset:3072 nt lds
    s_add_u32 m0, s89, 12288
    s_add_u32 s92, s71, 36864
    buffer_load_dwordx4 v112, s[48:51], s92 offen offset:0 nt lds
    buffer_load_dwordx4 v112, s[48:51], s92 offen offset:1024 nt lds
    buffer_load_dwordx4 v113, s[48:51], s92 offen offset:2048 nt lds
    buffer_load_dwordx4 v113, s[48:51], s92 offen offset:3072 nt lds
    s_waitcnt vmcnt(18) lgkmcnt(6)
    ds_read_b128 a[96:99], v92 offset:24576
    ds_read_b128 a[100:103], v93 offset:24576
    ds_read_b128 a[104:107], v94 offset:24576
    ds_read_b128 a[108:111], v95 offset:24576
    ds_read_b128 a[112:115], v92 offset:28672
    ds_read_b128 a[116:119], v93 offset:28672
    ds_read_b128 a[120:123], v94 offset:28672
    ds_read_b128 a[124:127], v95 offset:28672
    s_waitcnt lgkmcnt(8)
    s_add_u32 m0, s89, 16384
    s_add_u32 s92, s71, 65536
    buffer_load_dwordx4 v112, s[48:51], s92 offen offset:0 nt lds
    buffer_load_dwordx4 v112, s[48:51], s92 offen offset:1024 nt lds
    buffer_load_dwordx4 v113, s[48:51], s92 offen offset:2048 nt lds
    buffer_load_dwordx4 v113, s[48:51], s92 offen offset:3072 nt lds
    s_add_u32 m0, s89, 20480
    s_add_u32 s92, s71, 69632
    buffer_load_dwordx4 v112, s[48:51], s92 offen offset:0 nt lds
    buffer_load_dwordx4 v112, s[48:51], s92 offen offset:1024 nt lds
    buffer_load_dwordx4 v113, s[48:51], s92 offen offset:2048 nt lds
    buffer_load_dwordx4 v113, s[48:51], s92 offen offset:3072 nt lds
    s_waitcnt vmcnt(16)
    v_xor_b32 v24, s56, v33
    v_xor_b32 v25, s56, v35
    v_xor_b32 v26, s56, v37
    v_xor_b32 v27, s56, v39
    v_or3_b32 v24, v24, v25, v26
    v_or_b32 v24, v24, v27
    v_cmp_ne_u32 vcc, 0, v24
    s_cbranch_vccnz Lq_1
Lq_3:
    s_waitcnt lgkmcnt(4)
    ds_write2_b32 v126, v32, v34 offset0:0 offset1:1
    ds_write2_b32 v126, v36, v38 offset0:160 offset1:161
    ds_read_b128 v[64:67], v9 offset:0
    ds_read_b128 v[68:71], v9 offset:64
    ds_read_b128 v[72:75], v9 offset:128
    ds_read_b128 v[76:79], v9 offset:192
    s_waitcnt lgkmcnt(0)
    v_mfma_f32_16x16x32_bf16 v[32:35], v[64:67], a[0:3], 0
    v_mfma_f32_16x16x32_bf16 v[32:35], v[68:71], a[4:7], v[32:35]
    v_mfma_f32_16x16x32_bf16 v[32:35], v[72:75], a[8:11], v[32:35]
    v_mfma_f32_16x16x32_bf16 v[32:35], v[76:79], a[12:15], v[32:35]
    s_add_u32 m0, s89, 24576
    s_add_u32 s92, s71, 98304
    buffer_load_dwordx4 v112, s[48:51], s92 offen offset:0 nt lds
    v_mfma_f32_16x16x32_bf16 v[36:39], v[64:67], a[16:19], 0
    v_mfma_f32_16x16x32_bf16 v[36:39], v[68:71], a[20:23], v[36:39]
    v_mfma_f32_16x16x32_bf16 v[36:39], v[72:75], a[24:27], v[36:39]
    v_mfma_f32_16x16x32_bf16 v[36:39], v[76:79], a[28:31], v[36:39]
    buffer_load_dwordx4 v112, s[48:51], s92 offen offset:1024 nt lds
    v_mfma_f32_16x16x32_bf16 v[40:43], v[64:67], a[32:35], 0
    v_mfma_f32_16x16x32_bf16 v[40:43], v[68:71], a[36:39], v[40:43]
    v_mfma_f32_16x16x32_bf16 v[40:43], v[72:75], a[40:43], v[40:43]
    v_add_f32 v32, v32, v33
    v_add_f32 v34, v34, v35
    v_mfma_f32_16x16x32_bf16 v[40:43], v[76:79], a[44:47], v[40:43]
    v_add_f32 v32, v32, v34
    buffer_load_dwordx4 v113, s[48:51], s92 offen offset:2048 nt lds
    v_mfma_f32_16x16x32_bf16 v[44:47], v[64:67], a[48:51], 0
    v_mfma_f32_16x16x32_bf16 v[44:47], v[68:71], a[52:55], v[44:47]
    v_mfma_f32_16x16x32_bf16 v[44:47], v[72:75], a[56:59], v[44:47]
    v_add_f32 v36, v36, v37
    v_add_f32 v38, v38, v39
    v_mfma_f32_16x16x32_bf16 v[44:47], v[76:79], a[60:63], v[44:47]
    v_add_f32 v36, v36, v38
    buffer_load_dwordx4 v113, s[48:51], s92 offen offset:3072 nt lds
    v_mfma_f32_16x16x32_bf16 v[48:51], v[64:67], a[64:67], 0
    v_mfma_f32_16x16x32_bf16 v[48:51], v[68:71], a[68:71], v[48:51]
    v_mfma_f32_16x16x32_bf16 v[48:51], v[72:75], a[72:75], v[48:51]
    v_add_f32 v40, v40, v41
    v_add_f32 v42, v42, v43
    v_mfma_f32_16x16x32_bf16 v[48:51], v[76:79], a[76:79], v[48:51]
    v_add_f32 v40, v40, v42
    s_add_u32 m0, s89, 28672
    s_add_u32 s92, s71, 102400
    buffer_load_dwordx4 v112, s[48:51], s92 offen offset:0 nt lds
    v_mfma_f32_16x16x32_bf16 v[52:55], v[64:67], a[80:83], 0
    v_mfma_f32_16x16x32_bf16 v[52:55], v[68:71], a[84:87], v[52:55]
    v_mfma_f32_16x16x32_bf16 v[52:55], v[72:75], a[88:91], v[52:55]
    v_add_f32 v44, v44, v45
    v_add_f32 v46, v46, v47
    v_mfma_f32_16x16x32_bf16 v[52:55], v[76:79], a[92:95], v[52:55]
    v_add_f32 v44, v44, v46
    buffer_load_dwordx4 v112, s[48:51], s92 offen offset:1024 nt lds
    v_mfma_f32_16x16x32_bf16 v[56:59], v[64:67], a[96:99], 0
    v_mfma_f32_16x16x32_bf16 v[56:59], v[68:71], a[100:103], v[56:59]
    v_mfma_f32_16x16x32_bf16 v[56:59], v[72:75], a[104:107], v[56:59]
    v_add_f32 v48, v48, v49
    v_add_f32 v50, v50, v51
    v_mfma_f32_16x16x32_bf16 v[56:59], v[76:79], a[108:111], v[56:59]
    v_add_f32 v48, v48, v50
    v_cndmask_b32 v24, v32, v36, s[72:73]
    buffer_load_dwordx4 v113, s[48:51], s92 offen offset:2048 nt lds
    v_mfma_f32_16x16x32_bf16 v[60:63], v[64:67], a[112:115], 0
    v_mfma_f32_16x16x32_bf16 v[60:63], v[68:71], a[116:119], v[60:63]
    v_mfma_f32_16x16x32_bf16 v[60:63], v[72:75], a[120:123], v[60:63]
    v_cndmask_b32 v24, v24, v40, s[74:75]
    v_cndmask_b32 v24, v24, v44, s[76:77]
    v_mfma_f32_16x16x32_bf16 v[60:63], v[76:79], a[124:127], v[60:63]
    v_mul_f32 v24, s82, v24
    v_add_f32 v52, v52, v53
    buffer_load_dwordx4 v113, s[48:51], s92 offen offset:3072 nt lds
    v_add_f32 v54, v54, v55
    v_add_f32 v52, v52, v54
    v_add_f32 v56, v56, v57
    v_add_f32 v58, v58, v59
    v_add_f32 v56, v56, v58
    v_add_f32 v60, v60, v61
    v_add_f32 v62, v62, v63
    v_add_f32 v60, v60, v62
    v_cndmask_b32 v25, v48, v52, s[72:73]
    v_cndmask_b32 v25, v25, v56, s[74:75]
    v_cndmask_b32 v25, v25, v60, s[76:77]
    v_mul_f32 v25, s82, v25
    v_max_f32 v26, v24, v25
    s_nop 1
    v_max_f32_dpp v26, v26, v26 row_shr:1 row_mask:0xf bank_mask:0xf
    s_nop 1
    v_max_f32_dpp v26, v26, v26 row_shr:2 row_mask:0xf bank_mask:0xf
    s_nop 1
    v_max_f32_dpp v26, v26, v26 row_shr:4 row_mask:0xf bank_mask:0xf
    s_nop 1
    v_max_f32_dpp v26, v26, v26 row_shr:8 row_mask:0xf bank_mask:0xf
    s_nop 1
    v_max_f32_dpp v26, v26, v26 row_bcast:15 row_mask:0xa bank_mask:0xf
    s_nop 1
    v_max_f32_dpp v26, v26, v26 row_bcast:31 row_mask:0xc bank_mask:0xf
    s_nop 0
    v_readlane_b32 s87, v26, 63
    s_nop 1
    v_subrev_f32 v24, s87, v24
    v_subrev_f32 v25, s87, v25
    v_exp_f32 v24, v24
    v_exp_f32 v25, v25
    s_nop 0
    v_cvt_pk_bf16_f32 v26, v24, v25
    ds_write_b16 v6, v26
    ds_write_b16_d16_hi v6, v26 offset:128
    ds_read_b128 v[64:67], v3 offset:0
    ds_read_b128 v[68:71], v3 offset:64
    ds_read_b128 v[72:75], v3 offset:128
    ds_read_b128 v[76:79], v3 offset:192
    v_add_f32 v30, v24, v25
    s_nop 1
    v_add_f32_dpp v30, v30, v30 row_shr:1 row_mask:0xf bank_mask:0xf
    s_nop 1
    v_add_f32_dpp v30, v30, v30 row_shr:2 row_mask:0xf bank_mask:0xf
    s_nop 1
    v_add_f32_dpp v30, v30, v30 row_shr:4 row_mask:0xf bank_mask:0xf
    s_nop 1
    v_add_f32_dpp v30, v30, v30 row_shr:8 row_mask:0xf bank_mask:0xf
    s_nop 1
    v_add_f32_dpp v30, v30, v30 row_bcast:15 row_mask:0xa bank_mask:0xf
    s_nop 1
    v_add_f32_dpp v30, v30, v30 row_bcast:31 row_mask:0xc bank_mask:0xf
    s_nop 0
    v_readlane_b32 s88, v30, 63
    s_waitcnt vmcnt(26) lgkmcnt(0)
    ds_read_b64_tr_b16 v[128:129], v114 offset:0
    ds_read_b64_tr_b16 v[130:131], v114 offset:1024
    ds_read_b64_tr_b16 v[144:145], v115 offset:0
    ds_read_b64_tr_b16 v[146:147], v115 offset:1024
    ds_read_b64_tr_b16 v[160:161], v116 offset:0
    ds_read_b64_tr_b16 v[162:163], v116 offset:1024
    ds_read_b64_tr_b16 v[176:177], v117 offset:0
    ds_read_b64_tr_b16 v[178:179], v117 offset:1024
    ds_read_b64_tr_b16 v[192:193], v118 offset:0
    ds_read_b64_tr_b16 v[194:195], v118 offset:1024
    ds_read_b64_tr_b16 v[208:209], v119 offset:0
    ds_read_b64_tr_b16 v[210:211], v119 offset:1024
    s_waitcnt lgkmcnt(10)
    v_mfma_f32_16x16x32_bf16 v[32:35], v[64:67], v[128:131], 0
    ds_read_b64_tr_b16 v[224:225], v120 offset:0
    ds_read_b64_tr_b16 v[226:227], v120 offset:1024
    s_waitcnt lgkmcnt(10)
    v_mfma_f32_16x16x32_bf16 v[36:39], v[64:67], v[144:147], 0
    ds_read_b64_tr_b16 v[240:241], v121 offset:0
    ds_read_b64_tr_b16 v[242:243], v121 offset:1024
    s_waitcnt lgkmcnt(10)
    v_mfma_f32_16x16x32_bf16 v[40:43], v[64:67], v[160:163], 0
    s_waitcnt lgkmcnt(8)
    v_mfma_f32_16x16x32_bf16 v[44:47], v[64:67], v[176:179], 0
    s_waitcnt lgkmcnt(6)
    v_mfma_f32_16x16x32_bf16 v[48:51], v[64:67], v[192:195], 0
    s_waitcnt lgkmcnt(4)
    v_mfma_f32_16x16x32_bf16 v[52:55], v[64:67], v[208:211], 0
    s_waitcnt lgkmcnt(2)
    v_mfma_f32_16x16x32_bf16 v[56:59], v[64:67], v[224:227], 0
    s_waitcnt lgkmcnt(0)
    v_mfma_f32_16x16x32_bf16 v[60:63], v[64:67], v[240:243], 0
    s_waitcnt vmcnt(16)
    ds_read_b64_tr_b16 v[132:133], v114 offset:8192
    ds_read_b64_tr_b16 v[134:135], v114 offset:9216
    ds_read_b64_tr_b16 v[148:149], v115 offset:8192
    ds_read_b64_tr_b16 v[150:151], v115 offset:9216
    ds_read_b64_tr_b16 v[164:165], v116 offset:8192
    ds_read_b64_tr_b16 v[166:167], v116 offset:9216
    ds_read_b64_tr_b16 v[180:181], v117 offset:8192
    ds_read_b64_tr_b16 v[182:183], v117 offset:9216
    ds_read_b64_tr_b16 v[196:197], v118 offset:8192
    ds_read_b64_tr_b16 v[198:199], v118 offset:9216
    ds_read_b64_tr_b16 v[212:213], v119 offset:8192
    ds_read_b64_tr_b16 v[214:215], v119 offset:9216
    s_waitcnt lgkmcnt(10)
    v_mfma_f32_16x16x32_bf16 v[32:35], v[68:71], v[132:135], v[32:35]
    ds_read_b64_tr_b16 v[228:229], v120 offset:8192
    ds_read_b64_tr_b16 v[230:231], v120 offset:9216
    s_waitcnt lgkmcnt(10)
    v_mfma_f32_16x16x32_bf16 v[36:39], v[68:71], v[148:151], v[36:39]
    ds_read_b64_tr_b16 v[244:245], v121 offset:8192
    ds_read_b64_tr_b16 v[246:247], v121 offset:9216
    s_waitcnt lgkmcnt(10)
    v_mfma_f32_16x16x32_bf16 v[40:43], v[68:71], v[164:167], v[40:43]
    s_waitcnt lgkmcnt(8)
    v_mfma_f32_16x16x32_bf16 v[44:47], v[68:71], v[180:183], v[44:47]
    s_waitcnt lgkmcnt(6)
    v_mfma_f32_16x16x32_bf16 v[48:51], v[68:71], v[196:199], v[48:51]
    s_waitcnt lgkmcnt(4)
    v_mfma_f32_16x16x32_bf16 v[52:55], v[68:71], v[212:215], v[52:55]
    s_waitcnt lgkmcnt(2)
    v_mfma_f32_16x16x32_bf16 v[56:59], v[68:71], v[228:231], v[56:59]
    s_waitcnt lgkmcnt(0)
    v_mfma_f32_16x16x32_bf16 v[60:63], v[68:71], v[244:247], v[60:63]
    s_waitcnt vmcnt(8)
    ds_read_b64_tr_b16 v[136:137], v114 offset:16384
    ds_read_b64_tr_b16 v[138:139], v114 offset:17408
    ds_read_b64_tr_b16 v[152:153], v115 offset:16384
    ds_read_b64_tr_b16 v[154:155], v115 offset:17408
    ds_read_b64_tr_b16 v[168:169], v116 offset:16384
    ds_read_b64_tr_b16 v[170:171], v116 offset:17408
    ds_read_b64_tr_b16 v[184:185], v117 offset:16384
    ds_read_b64_tr_b16 v[186:187], v117 offset:17408
    ds_read_b64_tr_b16 v[200:201], v118 offset:16384
    ds_read_b64_tr_b16 v[202:203], v118 offset:17408
    ds_read_b64_tr_b16 v[216:217], v119 offset:16384
    ds_read_b64_tr_b16 v[218:219], v119 offset:17408
    s_waitcnt lgkmcnt(10)
    v_mfma_f32_16x16x32_bf16 v[32:35], v[72:75], v[136:139], v[32:35]
    ds_read_b64_tr_b16 v[232:233], v120 offset:16384
    ds_read_b64_tr_b16 v[234:235], v120 offset:17408
    s_waitcnt lgkmcnt(10)
    v_mfma_f32_16x16x32_bf16 v[36:39], v[72:75], v[152:155], v[36:39]
    ds_read_b64_tr_b16 v[248:249], v121 offset:16384
    ds_read_b64_tr_b16 v[250:251], v121 offset:17408
    s_waitcnt lgkmcnt(10)
    v_mfma_f32_16x16x32_bf16 v[40:43], v[72:75], v[168:171], v[40:43]
    s_waitcnt lgkmcnt(8)
    v_mfma_f32_16x16x32_bf16 v[44:47], v[72:75], v[184:187], v[44:47]
    s_waitcnt lgkmcnt(6)
    v_mfma_f32_16x16x32_bf16 v[48:51], v[72:75], v[200:203], v[48:51]
    s_waitcnt lgkmcnt(4)
    v_mfma_f32_16x16x32_bf16 v[52:55], v[72:75], v[216:219], v[52:55]
    s_waitcnt lgkmcnt(2)
    v_mfma_f32_16x16x32_bf16 v[56:59], v[72:75], v[232:235], v[56:59]
    s_waitcnt lgkmcnt(0)
    v_mfma_f32_16x16x32_bf16 v[60:63], v[72:75], v[248:251], v[60:63]
    s_waitcnt vmcnt(0)
    s_add_u32 m0, s89, 0x1000
    s_nop 0
    buffer_load_dwordx4 v124, s[52:55], s42 offen nt lds
    s_add_u32 m0, s89, 0x13c0
    s_nop 0
    buffer_load_dwordx4 v124, s[52:55], s42 offen offset:64 nt lds
    ds_read_b64_tr_b16 v[140:141], v114 offset:24576
    ds_read_b64_tr_b16 v[142:143], v114 offset:25600
    ds_read_b64_tr_b16 v[156:157], v115 offset:24576
    ds_read_b64_tr_b16 v[158:159], v115 offset:25600
    ds_read_b64_tr_b16 v[172:173], v116 offset:24576
    ds_read_b64_tr_b16 v[174:175], v116 offset:25600
    ds_read_b64_tr_b16 v[188:189], v117 offset:24576
    ds_read_b64_tr_b16 v[190:191], v117 offset:25600
    ds_read_b64_tr_b16 v[204:205], v118 offset:24576
    ds_read_b64_tr_b16 v[206:207], v118 offset:25600
    ds_read_b64_tr_b16 v[220:221], v119 offset:24576
    ds_read_b64_tr_b16 v[222:223], v119 offset:25600
    s_waitcnt lgkmcnt(10)
    v_mfma_f32_16x16x32_bf16 v[32:35], v[76:79], v[140:143], v[32:35]
    ds_read_b64_tr_b16 v[236:237], v120 offset:24576
    ds_read_b64_tr_b16 v[238:239], v120 offset:25600
    s_waitcnt lgkmcnt(10)
    v_mfma_f32_16x16x32_bf16 v[36:39], v[76:79], v[156:159], v[36:39]
    ds_read_b64_tr_b16 v[252:253], v121 offset:24576
    ds_read_b64_tr_b16 v[254:255], v121 offset:25600
    s_waitcnt lgkmcnt(10)
    v_mfma_f32_16x16x32_bf16 v[40:43], v[76:79], v[172:175], v[40:43]
    s_waitcnt lgkmcnt(8)
    v_mfma_f32_16x16x32_bf16 v[44:47], v[76:79], v[188:191], v[44:47]
    s_waitcnt lgkmcnt(6)
    v_mfma_f32_16x16x32_bf16 v[48:51], v[76:79], v[204:207], v[48:51]
    s_waitcnt lgkmcnt(4)
    v_mfma_f32_16x16x32_bf16 v[52:55], v[76:79], v[220:223], v[52:55]
    s_waitcnt lgkmcnt(2)
    v_mfma_f32_16x16x32_bf16 v[56:59], v[76:79], v[236:239], v[56:59]
    s_waitcnt lgkmcnt(0)
    v_mfma_f32_16x16x32_bf16 v[60:63], v[76:79], v[252:255], v[60:63]
    v_mov_b32 v26, s87
    v_mov_b32 v27, s88
    ds_write2_b32 v8, v26, v27 offset0:0 offset1:4
    v_cndmask_b32 v24, v32, v36, s[72:73]
    v_cndmask_b32 v24, v24, v40, s[74:75]
    v_cndmask_b32 v24, v24, v44, s[76:77]
    v_cndmask_b32 v25, v48, v52, s[72:73]
    v_cndmask_b32 v25, v25, v56, s[74:75]
    v_cndmask_b32 v25, v25, v60, s[76:77]
    ds_write2st64_b32 v7, v24, v25 offset0:0 offset1:1
    s_waitcnt lgkmcnt(0)
    s_barrier
    v_lshlrev_b32 v14, 16, v14
    v_mov_b32 v24, 0x26000
    ds_read_b32 v24, v24 offset:32
    v_mov_b32 v64, s83
    v_mov_b32 v65, s83
    s_lshl_b32 s85, s5, 6
    s_add_u32 s87, s38, s85
    s_lshl_b32 s85, s3, 13
    s_add_u32 s87, s87, s85
    s_add_u32 s87, s87, 0xa000
    s_waitcnt vmcnt(0) lgkmcnt(0)
    v_readfirstlane_b32 s81, v24
    ds_read_b64_tr_b16 a[192:193], v4 offset:4096
    ds_read_b64_tr_b16 a[194:195], v4 offset:4608
    ds_read_b64_tr_b16 a[196:197], v4 offset:5120
    ds_read_b64_tr_b16 a[198:199], v4 offset:5632
    s_waitcnt lgkmcnt(0)
    v_mfma_f32_16x16x16_bf16 v[32:35], v[64:65], a[192:193], 0
    v_mfma_f32_16x16x16_bf16 v[36:39], v[64:65], a[194:195], 0
    v_mfma_f32_16x16x16_bf16 v[40:43], v[64:65], a[196:197], 0
    v_mfma_f32_16x16x16_bf16 v[44:47], v[64:65], a[198:199], 0
    s_nop 5
    v_cndmask_b32 v24, v32, v36, s[72:73]
    v_cndmask_b32 v24, v24, v40, s[74:75]
    v_cndmask_b32 v24, v24, v44, s[76:77]
    v_min_u32 v24, -2, v24
    s_cmp_eq_u32 s81, 0
    s_cbranch_scc1 Lslow_4
    buffer_store_dword v24, v11, s[8:11], s87 offen
Ljoin_5:
    v_lshlrev_b32 v17, 2, v0
    s_and_b32 s85, s5, 3
    s_mul_i32 s85, s85, 3
    s_add_u32 s85, s85, s3
    s_lshl_b32 s85, s85, 8
    s_add_u32 s57, s85, s67
    s_barrier
    s_mov_b32 m0, s89
    s_lshl_b32 s85, s3, 14
    s_add_u32 s93, s43, s85
    buffer_load_dwordx4 v122, s[12:15], s93 offen nt lds
    s_add_u32 m0, m0, 1024
    s_add_u32 s93, s93, 8192
    buffer_load_dwordx4 v123, s[12:15], s93 offen nt lds
    v_mov_b32 v96, -1
    v_mov_b32 v97, -1
    v_mov_b32 v98, -1
    v_mov_b32 v99, -1
    s_cmp_eq_u32 s3, 2
    s_cbranch_scc1 L_lrx
    s_lshl_b32 s85, s5, 1
    s_add_u32 s85, s85, s3
    s_mul_i32 s85, s85, 640
    s_add_u32 s85, s85, s38
    s_add_u32 s85, s85, 0xc0000
    s_mov_b32 exec_hi, 0xff
    s_cmp_eq_u32 s81, 0
    s_cbranch_scc1 Lslow_6
    buffer_store_dwordx4 v[96:99], v1, s[8:11], s85 offen
Ljoin_7:
    s_mov_b32 exec_hi, -1
    s_branch L_nolr
L_lrx:
L_nolr:
    buffer_load_dwordx4 v[112:115], v1, s[8:11], s90 offen offset:0 sc1
    buffer_load_dwordx4 v[112:115], v1, s[8:11], s90 offen offset:1024 sc1
    buffer_load_dwordx4 v[112:115], v1, s[8:11], s67 offen offset:0 sc1
    buffer_load_dword v112, v17, s[8:11], s57 offen offset:1024 sc1
    s_add_u32 s87, s90, 0x8000
Lpoll_8:
    buffer_load_dwordx4 v[112:115], v1, s[8:11], s87 offen sc1
    buffer_load_dwordx4 v[116:119], v1, s[8:11], s87 offen offset:1024 sc1
    s_add_u32 s84, s84, 1
    s_cmp_gt_u32 s84, 400000
    s_waitcnt vmcnt(0)
    s_cbranch_scc1 Lpout_9
    v_max_u32 v31, v112, v113
    v_max3_u32 v31, v31, v114, v115
    v_max3_u32 v31, v31, v116, v117
    v_max3_u32 v31, v31, v118, v119
    v_cmp_eq_u32 vcc, -1, v31
    s_cbranch_vccnz Lpoll_8
Lpout_9:
    v_add_f32 v64, v112, v116
    v_add_f32 v65, v113, v117
    v_add_f32 v66, v114, v118
    v_add_f32 v67, v115, v119
    v_permlane32_swap_b32 v64, v65
    s_nop 0
    v_permlane32_swap_b32 v66, v67
    v_add_f32 v64, v64, v65
    v_add_f32 v66, v66, v67
    s_nop 1
    v_permlane16_swap_b32 v64, v66
    v_add_f32 v24, v64, v66
    s_nop 1
    v_add_f32_dpp v24, v24, v24 row_ror:4 row_mask:0xf bank_mask:0xf
    s_nop 1
    v_add_f32_dpp v24, v24, v24 row_ror:8 row_mask:0xf bank_mask:0xf
    v_mov_b32 v15, v24
L_loopA:
    v_mov_b32 v26, 0xc0135761
    v_mov_b32 v25, 0x3b000000
    s_barrier
    buffer_load_dwordx4 v[112:115], v1, s[8:11], s90 offen sc1
    buffer_load_dwordx4 v[116:119], v1, s[8:11], s90 offen offset:1024 sc1
    buffer_load_dword v120, v17, s[8:11], s57 offen offset:1024 sc1
    s_lshl_b32 s85, s3, 5
    v_and_b32 v27, 0x800, v127
    v_xor_b32 v30, v27, v127
    v_lshl_add_u32 v30, v27, 4, v30
    v_xor_b32 v30, s85, v30
    ds_read_b64_tr_b16 a[232:233], v30 offset:0
    ds_read_b64_tr_b16 a[234:235], v30 offset:512
    s_add_u32 s85, s85, 0x10000
    v_lshrrev_b32 v30, 2, v0
    v_lshlrev_b32 v30, 7, v30
    v_and_b32 v27, 3, v0
    v_lshl_add_u32 v30, v27, 3, v30
    v_bfe_u32 v27, v0, 3, 1
    v_lshl_add_u32 v30, v27, 5, v30
    v_lshrrev_b32 v27, 5, v0
    v_lshl_add_u32 v30, v27, 6, v30
    v_xor_b32 v30, s85, v30
    ds_read_b64_tr_b16 a[236:237], v30 offset:0
Lpoll_10:
    buffer_load_dwordx4 v[112:115], v1, s[8:11], s90 offen sc1
    buffer_load_dwordx4 v[116:119], v1, s[8:11], s90 offen offset:1024 sc1
    buffer_load_dword v120, v17, s[8:11], s57 offen offset:1024 sc1
    s_add_u32 s84, s84, 1
    s_cmp_gt_u32 s84, 400000
    s_waitcnt vmcnt(3)
    s_cbranch_scc1 Lpout_11
    v_max_u32 v31, v112, v113
    v_max3_u32 v31, v31, v114, v115
    v_max3_u32 v31, v31, v116, v117
    v_max3_u32 v31, v31, v118, v119
    v_max3_u32 v31, v31, v120, v120
    v_cmp_eq_u32 vcc, -1, v31
    s_cbranch_vccnz Lpoll_10
Lpout_11:
    v_add_f32_dpp v28, v120, v120 row_ror:2 row_mask:0xf bank_mask:0xf
    v_add_f32 v64, v112, v116
    v_add_f32 v65, v113, v117
    v_add_f32_dpp v28, v28, v28 row_ror:4 row_mask:0xf bank_mask:0xf
    v_add_f32 v66, v114, v118
    v_add_f32 v67, v115, v119
    v_add_f32_dpp v28, v28, v28 row_ror:8 row_mask:0xf bank_mask:0xf
    v_permlane32_swap_b32 v64, v65
    v_mov_b32 v29, v28
    v_permlane32_swap_b32 v66, v67
    v_add_f32 v64, v64, v65
    v_permlane32_swap_b32 v28, v29
    v_add_f32 v66, v66, v67
    v_add_f32 v28, v28, v29
    v_mov_b32 v29, v28
    v_permlane16_swap_b32 v64, v66
    v_add_f32 v24, v64, v66
    v_permlane16_swap_b32 v28, v29
    v_add_f32 v28, v28, v29
    v_add_f32_dpp v24, v24, v24 row_ror:4 row_mask:0xf bank_mask:0xf
    s_nop 0
    v_mul_f32_dpp v29, v28, v25 quad_perm:[1,1,3,3] row_mask:0xf bank_mask:0xf
    v_mul_f32_dpp v28, v28, v25 quad_perm:[0,0,2,2] row_mask:0xf bank_mask:0xf
    v_add_f32_dpp v24, v24, v24 row_ror:8 row_mask:0xf bank_mask:0xf
    v_fma_f32 v29, -v28, v28, v29
    v_max_f32 v29, 0, v29
    v_add_f32 v29, 0x3727c5ac, v29
    v_rsq_f32 v29, v29
    v_fma_f32 v24, -v28, v15, v24
    v_mov_b32 v28, v14
    v_fma_f32 v24, v24, v29, v28
    v_mul_f32 v25, v24, v24
    v_fmac_f32 v26, 0xbdd2d3e8, v25
    v_mul_f32 v26, v24, v26
    v_exp_f32 v26, v26
    s_nop 0
    v_add_f32 v26, 1.0, v26
    v_rcp_f32 v26, v26
    s_nop 0
    v_mul_f32 v24, v24, v26
    v_cvt_pk_bf16_f32 v24, v24, v24
    ds_write_b16 v16, v24
    s_waitcnt lgkmcnt(0)
    s_barrier
    ds_read_b128 v[64:67], v12
    ds_read_b64 v[68:69], v13
    s_waitcnt lgkmcnt(0)
    v_mfma_f32_16x16x32_bf16 v[32:35], v[64:67], a[232:235], 0
    v_mfma_f32_16x16x16_bf16 v[36:39], v[68:69], a[236:237], 0
    s_nop 7
    v_add_f32 v24, v32, v36
    v_min_u32 v24, -2, v24
    s_mov_b64 exec, 0xffff
    buffer_store_dword v24, v11, s[8:11], s69 offen sc1
    s_mov_b64 exec, -1
    s_cmp_eq_u32 s80, 1
    s_cbranch_scc1 L_endA
    s_lshl_b32 s85, s3, 11
    s_add_u32 s85, s85, 0x24000
    v_and_b32 v24, 1, v0
    v_mul_u32_u24 v126, 0xaaaa, v24
    v_add_u32 v126, 0x4444, v126
    v_mul_u32_u24 v124, 160, v24
    v_lshrrev_b32 v25, 4, v0
    v_lshl_add_u32 v124, v25, 4, v124
    v_add_u32 v124, s85, v124
    v_bfe_u32 v25, v0, 1, 1
    v_mul_u32_u24 v123, 160, v25
    v_lshl_add_u32 v123, v24, 1, v123
    v_and_b32 v25, 0x3c, v0
    v_add3_u32 v123, v123, v25, s85
    v_mov_b32 v32, 0
    v_mov_b32 v33, 0
    v_mov_b32 v34, 0
    v_mov_b32 v35, 0
    v_mov_b32 v36, 0
    v_mov_b32 v37, 0
    v_mov_b32 v38, 0
    v_mov_b32 v39, 0
    v_mov_b32 v40, 0
    v_mov_b32 v41, 0
    v_mov_b32 v42, 0
    v_mov_b32 v43, 0
    v_mov_b32 v44, 0
    v_mov_b32 v45, 0
    v_mov_b32 v46, 0
    v_mov_b32 v47, 0
    v_mov_b32 v48, 0
    v_mov_b32 v49, 0
    v_mov_b32 v50, 0
    v_mov_b32 v51, 0
    v_mov_b32 v52, 0
    v_mov_b32 v53, 0
    v_mov_b32 v54, 0
    v_mov_b32 v55, 0
    v_mov_b32 v56, 0
    v_mov_b32 v57, 0
    v_mov_b32 v58, 0
    v_mov_b32 v59, 0
    v_mov_b32 v60, 0
    v_mov_b32 v61, 0
    v_mov_b32 v62, 0
    v_mov_b32 v63, 0
    buffer_load_dwordx4 v[112:115], v1, s[8:11], s70 offen sc1
    s_mov_b32 s85, s62
    s_mov_b32 s86, s63
    s_mov_b32 s80, 1
    s_add_u32 s8, s8, 0xc0000
    s_addc_u32 s9, s9, 0
    s_barrier
    ds_read_b128 v[64:67], v23 offset:0
    ds_read_b128 v[68:71], v23 offset:64
    s_waitcnt lgkmcnt(1)
    v_smfmac_f32_16x16x64_bf16 v[32:35], v[64:67], a[0:7], v126
    buffer_load_dwordx4 v[112:115], v1, s[8:11], s85 offen offset:0 sc1
    s_waitcnt lgkmcnt(0)
    v_smfmac_f32_16x16x64_bf16 v[32:35], v[68:71], a[8:15], v126
    buffer_load_dwordx4 v[112:115], v1, s[8:11], s85 offen offset:1024 sc1
    v_smfmac_f32_16x16x64_bf16 v[36:39], v[64:67], a[16:23], v126
    buffer_load_dwordx4 v[112:115], v1, s[8:11], s90 offen offset:0 sc1
    v_smfmac_f32_16x16x64_bf16 v[36:39], v[68:71], a[24:31], v126
    buffer_load_dwordx4 v[112:115], v1, s[8:11], s90 offen offset:1024 sc1
    v_smfmac_f32_16x16x64_bf16 v[40:43], v[64:67], a[32:39], v126
    v_smfmac_f32_16x16x64_bf16 v[40:43], v[68:71], a[40:47], v126
    v_smfmac_f32_16x16x64_bf16 v[44:47], v[64:67], a[48:55], v126
    v_add_f32 v32, v32, v33
    v_add_f32 v34, v34, v35
    v_smfmac_f32_16x16x64_bf16 v[44:47], v[68:71], a[56:63], v126
    v_add_f32 v32, v32, v34
    v_smfmac_f32_16x16x64_bf16 v[48:51], v[64:67], a[64:71], v126
    v_add_f32 v36, v36, v37
    v_add_f32 v38, v38, v39
    v_smfmac_f32_16x16x64_bf16 v[48:51], v[68:71], a[72:79], v126
    v_add_f32 v36, v36, v38
    v_smfmac_f32_16x16x64_bf16 v[52:55], v[64:67], a[80:87], v126
    v_add_f32 v40, v40, v41
    v_add_f32 v42, v42, v43
    v_smfmac_f32_16x16x64_bf16 v[52:55], v[68:71], a[88:95], v126
    v_add_f32 v40, v40, v42
    v_smfmac_f32_16x16x64_bf16 v[56:59], v[64:67], a[96:103], v126
    v_add_f32 v44, v44, v45
    v_add_f32 v46, v46, v47
    v_smfmac_f32_16x16x64_bf16 v[56:59], v[68:71], a[104:111], v126
    v_add_f32 v44, v44, v46
    v_cndmask_b32 v24, v32, v40, s[78:79]
    v_smfmac_f32_16x16x64_bf16 v[60:63], v[64:67], a[112:119], v126
    v_cndmask_b32 v27, v36, v44, s[78:79]
    v_add_f32 v48, v48, v49
    v_smfmac_f32_16x16x64_bf16 v[60:63], v[68:71], a[120:127], v126
    v_add_f32 v50, v50, v51
    v_add_f32 v48, v48, v50
    v_add_f32 v52, v52, v53
    v_add_f32 v54, v54, v55
    v_add_f32 v52, v52, v54
    v_permlane16_swap_b32 v24, v27
    v_add_f32 v56, v56, v57
    v_add_f32 v58, v58, v59
    v_add_f32 v56, v56, v58
    v_add_f32 v24, v24, v27
    v_mul_f32 v24, s82, v24
    v_add_f32 v60, v60, v61
    v_add_f32 v62, v62, v63
    v_add_f32 v60, v60, v62
    v_cndmask_b32 v25, v48, v56, s[78:79]
    v_cndmask_b32 v28, v52, v60, s[78:79]
    v_mov_b32 v32, 0
    v_mov_b32 v33, 0
    v_permlane16_swap_b32 v25, v28
    v_add_f32 v25, v25, v28
    v_mul_f32 v25, s82, v25
    v_max_f32 v26, v24, v25
    v_mov_b32 v36, 0
    v_mov_b32 v37, 0
    v_max_f32_dpp v26, v26, v26 row_shr:1 row_mask:0xf bank_mask:0xf
    v_mov_b32 v40, 0
    v_mov_b32 v41, 0
    v_max_f32_dpp v26, v26, v26 row_shr:2 row_mask:0xf bank_mask:0xf
    v_mov_b32 v44, 0
    v_mov_b32 v45, 0
    v_max_f32_dpp v26, v26, v26 row_shr:4 row_mask:0xf bank_mask:0xf
    v_mov_b32 v48, 0
    v_mov_b32 v49, 0
    v_max_f32_dpp v26, v26, v26 row_shr:8 row_mask:0xf bank_mask:0xf
    v_mov_b32 v52, 0
    v_mov_b32 v53, 0
    v_max_f32_dpp v26, v26, v26 row_bcast:15 row_mask:0xa bank_mask:0xf
    v_mov_b32 v56, 0
    v_mov_b32 v57, 0
    v_max_f32_dpp v26, v26, v26 row_bcast:31 row_mask:0xc bank_mask:0xf
    v_mov_b32 v60, 0
    v_readlane_b32 s87, v26, 63
    v_mov_b32 v61, 0
    buffer_load_dword v112, v17, s[8:11], s86 offen sc1
    v_subrev_f32 v24, s87, v24
    v_subrev_f32 v25, s87, v25
    v_exp_f32 v24, v24
    v_exp_f32 v25, v25
    s_nop 0
    v_cvt_pk_bf16_f32 v26, v24, v25
    ds_write_b16 v123, v26
    ds_write_b16_d16_hi v123, v26 offset:64
    ds_read_b128 v[72:75], v124 offset:0
    ds_read_b128 v[76:79], v124 offset:64
    buffer_load_dword v112, v17, s[8:11], s57 offen offset:1024 sc1
    v_add_f32 v30, v24, v25
    v_mov_b32 v26, s87
    s_nop 0
    v_add_f32_dpp v30, v30, v30 row_shr:1 row_mask:0xf bank_mask:0xf
    s_nop 1
    v_add_f32_dpp v30, v30, v30 row_shr:2 row_mask:0xf bank_mask:0xf
    s_nop 1
    v_add_f32_dpp v30, v30, v30 row_shr:4 row_mask:0xf bank_mask:0xf
    s_nop 1
    v_add_f32_dpp v30, v30, v30 row_shr:8 row_mask:0xf bank_mask:0xf
    s_nop 1
    v_add_f32_dpp v30, v30, v30 row_bcast:15 row_mask:0xa bank_mask:0xf
    s_nop 1
    v_add_f32_dpp v30, v30, v30 row_bcast:31 row_mask:0xc bank_mask:0xf
    s_nop 0
    v_readlane_b32 s88, v30, 63
    s_waitcnt lgkmcnt(0)
    v_smfmac_f32_16x16x64_bf16 v[32:35], v[72:75], v[128:135], v126
    v_mov_b32 v27, s88
    v_smfmac_f32_16x16x64_bf16 v[32:35], v[76:79], v[136:143], v126
    ds_write2_b32 v8, v26, v27 offset0:0 offset1:4
    v_smfmac_f32_16x16x64_bf16 v[36:39], v[72:75], v[144:151], v126
    v_smfmac_f32_16x16x64_bf16 v[36:39], v[76:79], v[152:159], v126
    v_smfmac_f32_16x16x64_bf16 v[40:43], v[72:75], v[160:167], v126
    v_smfmac_f32_16x16x64_bf16 v[40:43], v[76:79], v[168:175], v126
    v_smfmac_f32_16x16x64_bf16 v[44:47], v[72:75], v[176:183], v126
    v_smfmac_f32_16x16x64_bf16 v[44:47], v[76:79], v[184:191], v126
    v_smfmac_f32_16x16x64_bf16 v[48:51], v[72:75], v[192:199], v126
    v_add_f32 v32, v32, v33
    v_smfmac_f32_16x16x64_bf16 v[48:51], v[76:79], v[200:207], v126
    v_smfmac_f32_16x16x64_bf16 v[52:55], v[72:75], v[208:215], v126
    v_add_f32 v36, v36, v37
    v_smfmac_f32_16x16x64_bf16 v[52:55], v[76:79], v[216:223], v126
    v_smfmac_f32_16x16x64_bf16 v[56:59], v[72:75], v[224:231], v126
    v_add_f32 v40, v40, v41
    v_smfmac_f32_16x16x64_bf16 v[56:59], v[76:79], v[232:239], v126
    v_smfmac_f32_16x16x64_bf16 v[60:63], v[72:75], v[240:247], v126
    v_add_f32 v44, v44, v45
    v_smfmac_f32_16x16x64_bf16 v[60:63], v[76:79], v[248:255], v126
    v_cndmask_b32 v24, v32, v36, s[72:73]
    v_cndmask_b32 v24, v24, v40, s[74:75]
    v_cndmask_b32 v24, v24, v44, s[76:77]
    v_add_f32 v48, v48, v49
    v_add_f32 v52, v52, v53
    v_add_f32 v56, v56, v57
    s_nop 1
    v_add_f32 v60, v60, v61
    v_cndmask_b32 v25, v48, v52, s[72:73]
    v_cndmask_b32 v25, v25, v56, s[74:75]
    v_cndmask_b32 v25, v25, v60, s[76:77]
    ds_write2st64_b32 v7, v24, v25 offset0:0 offset1:1
    s_waitcnt lgkmcnt(0)
    s_barrier
    s_branch L_loopA
L_endA:
    s_endpgm
L_w3:
    s_sub_u32 s68, s68, 96
    v_mul_u32_u24 v14, 144, v33
    v_lshl_add_u32 v14, v32, 4, v14
    v_add_u32 v14, 0x1e000, v14
    v_mul_u32_u24 v22, 288, v32
    v_lshl_add_u32 v22, v33, 3, v22
    v_add_u32 v22, 0x1e000, v22
    v_mov_b32 v15, 0x1e900
    v_lshlrev_b32 v16, 3, v32
    v_add_u32 v16, 0x1e900, v16
    v_lshlrev_b32 v17, 8, v33
    v_lshl_add_u32 v17, v32, 4, v17
    v_lshlrev_b32 v20, 3, v32
    s_lshl_b32 s85, s5, 5
    v_add_u32 v26, s85, v20
    global_load_dwordx2 v[80:81], v26, s[16:17]
    global_load_dwordx2 v[84:85], v26, s[34:35]
    v_lshlrev_b32 v18, 3, v0
    v_add_u32 v18, 0x26800, v18
    v_lshlrev_b32 v19, 2, v0
    s_lshl_b32 s85, s7, 8
    s_add_u32 s60, s62, s85
    s_lshl_b32 s85, s7, 2
    s_add_u32 s61, s63, s85
    s_lshl_b32 s65, s7, 13
    s_and_b32 s85, s5, 3
    s_lshl_b32 s85, s85, 6
    s_add_u32 s65, s65, s85
    s_lshl_b32 s85, s5, 5
    s_add_u32 s66, s67, s85
    s_lshl_b32 s85, s5, 6
    s_add_u32 s90, s90, s85
    s_lshl_b32 s42, s6, 17
    s_lshl_b32 s85, s7, 7
    s_add_u32 s42, s42, s85
    s_mov_b32 s52, s24
    s_and_b32 s53, s25, 0xffff
    s_mov_b32 s54, 0x400000
    s_mov_b32 s55, 0x20000
    s_add_u32 m0, s89, 20480
    s_add_u32 s91, s71, 69632
    buffer_load_dwordx4 v88, s[44:47], s91 offen offset:0 nt lds
    buffer_load_dwordx4 v89, s[44:47], s91 offen offset:1024 nt lds
    buffer_load_dwordx4 v90, s[44:47], s91 offen offset:2048 nt lds
    buffer_load_dwordx4 v91, s[44:47], s91 offen offset:3072 nt lds
    s_add_u32 m0, s89, 24576
    s_add_u32 s91, s71, 98304
    buffer_load_dwordx4 v88, s[44:47], s91 offen offset:0 nt lds
    buffer_load_dwordx4 v89, s[44:47], s91 offen offset:1024 nt lds
    buffer_load_dwordx4 v90, s[44:47], s91 offen offset:2048 nt lds
    buffer_load_dwordx4 v91, s[44:47], s91 offen offset:3072 nt lds
    s_add_u32 m0, s89, 28672
    s_add_u32 s91, s71, 102400
    buffer_load_dwordx4 v88, s[44:47], s91 offen offset:0 nt lds
    buffer_load_dwordx4 v89, s[44:47], s91 offen offset:1024 nt lds
    buffer_load_dwordx4 v90, s[44:47], s91 offen offset:2048 nt lds
    buffer_load_dwordx4 v91, s[44:47], s91 offen offset:3072 nt lds
    s_waitcnt vmcnt(27) lgkmcnt(6)
    ds_read_b128 a[0:3], v92 offset:0
    ds_read_b128 a[4:7], v93 offset:0
    ds_read_b128 a[8:11], v94 offset:0
    ds_read_b128 a[12:15], v95 offset:0
    ds_read_b128 a[16:19], v92 offset:4096
    ds_read_b128 a[20:23], v93 offset:4096
    ds_read_b128 a[24:27], v94 offset:4096
    ds_read_b128 a[28:31], v95 offset:4096
    s_waitcnt vmcnt(19) lgkmcnt(6)
    ds_read_b128 a[32:35], v92 offset:8192
    ds_read_b128 a[36:39], v93 offset:8192
    ds_read_b128 a[40:43], v94 offset:8192
    ds_read_b128 a[44:47], v95 offset:8192
    ds_read_b128 a[48:51], v92 offset:12288
    ds_read_b128 a[52:55], v93 offset:12288
    ds_read_b128 a[56:59], v94 offset:12288
    ds_read_b128 a[60:63], v95 offset:12288
    s_waitcnt lgkmcnt(8)
    buffer_load_dword v101, v99, s[8:11], s43 offen sc1
    s_add_u32 m0, s89, 0
    s_add_u32 s92, s71, 0
    buffer_load_dwordx4 v112, s[48:51], s92 offen offset:0 nt lds
    buffer_load_dwordx4 v112, s[48:51], s92 offen offset:1024 nt lds
    buffer_load_dwordx4 v113, s[48:51], s92 offen offset:2048 nt lds
    buffer_load_dwordx4 v113, s[48:51], s92 offen offset:3072 nt lds
    s_add_u32 m0, s89, 4096
    s_add_u32 s92, s71, 4096
    buffer_load_dwordx4 v112, s[48:51], s92 offen offset:0 nt lds
    buffer_load_dwordx4 v112, s[48:51], s92 offen offset:1024 nt lds
    buffer_load_dwordx4 v113, s[48:51], s92 offen offset:2048 nt lds
    buffer_load_dwordx4 v113, s[48:51], s92 offen offset:3072 nt lds
    buffer_load_dwordx4 v[32:35], v1, s[8:11], s57 offen offset:0 sc1
    buffer_load_dwordx4 v[36:39], v1, s[8:11], s57 offen offset:1024 sc1
    s_waitcnt vmcnt(19) lgkmcnt(6)
    ds_read_b128 a[64:67], v92 offset:16384
    ds_read_b128 a[68:71], v93 offset:16384
    ds_read_b128 a[72:75], v94 offset:16384
    ds_read_b128 a[76:79], v95 offset:16384
    ds_read_b128 a[80:83], v92 offset:20480
    ds_read_b128 a[84:87], v93 offset:20480
    ds_read_b128 a[88:91], v94 offset:20480
    ds_read_b128 a[92:95], v95 offset:20480
    s_waitcnt lgkmcnt(8)
    s_add_u32 m0, s89, 8192
    s_add_u32 s92, s71, 32768
    buffer_load_dwordx4 v112, s[48:51], s92 offen offset:0 nt lds
    buffer_load_dwordx4 v112, s[48:51], s92 offen offset:1024 nt lds
    buffer_load_dwordx4 v113, s[48:51], s92 offen offset:2048 nt lds
    buffer_load_dwordx4 v113, s[48:51], s92 offen offset:3072 nt lds
    s_waitcnt vmcnt(14)
    v_cmp_ne_u32 vcc, s56, v101
    s_cmp_eq_u64 vcc, 0
    s_cselect_b32 s81, 1, 0
    s_cmp_gt_u32 s81, s5
    s_cbranch_scc0 L_nof
    s_add_u32 s85, s43, 0x1000
    s_mov_b64 exec, 1
    buffer_store_dword v97, v98, s[8:11], s85 offen sc1
    s_mov_b64 exec, -1
L_nof:
    s_add_u32 m0, s89, 12288
    s_add_u32 s92, s71, 36864
    buffer_load_dwordx4 v112, s[48:51], s92 offen offset:0 nt lds
    buffer_load_dwordx4 v112, s[48:51], s92 offen offset:1024 nt lds
    buffer_load_dwordx4 v113, s[48:51], s92 offen offset:2048 nt lds
    buffer_load_dwordx4 v113, s[48:51], s92 offen offset:3072 nt lds
    s_waitcnt vmcnt(19) lgkmcnt(6)
    ds_read_b128 a[96:99], v92 offset:24576
    ds_read_b128 a[100:103], v93 offset:24576
    ds_read_b128 a[104:107], v94 offset:24576
    ds_read_b128 a[108:111], v95 offset:24576
    ds_read_b128 a[112:115], v92 offset:28672
    ds_read_b128 a[116:119], v93 offset:28672
    ds_read_b128 a[120:123], v94 offset:28672
    ds_read_b128 a[124:127], v95 offset:28672
    s_waitcnt lgkmcnt(8)
    s_add_u32 m0, s89, 16384
    s_add_u32 s92, s71, 65536
    buffer_load_dwordx4 v112, s[48:51], s92 offen offset:0 nt lds
    buffer_load_dwordx4 v112, s[48:51], s92 offen offset:1024 nt lds
    buffer_load_dwordx4 v113, s[48:51], s92 offen offset:2048 nt lds
    buffer_load_dwordx4 v113, s[48:51], s92 offen offset:3072 nt lds
    s_add_u32 m0, s89, 20480
    s_add_u32 s92, s71, 69632
    buffer_load_dwordx4 v112, s[48:51], s92 offen offset:0 nt lds
    buffer_load_dwordx4 v112, s[48:51], s92 offen offset:1024 nt lds
    buffer_load_dwordx4 v113, s[48:51], s92 offen offset:2048 nt lds
    buffer_load_dwordx4 v113, s[48:51], s92 offen offset:3072 nt lds
    s_waitcnt vmcnt(16)
    v_xor_b32 v24, s56, v33
    v_xor_b32 v25, s56, v35
    v_xor_b32 v26, s56, v37
    v_xor_b32 v27, s56, v39
    v_or3_b32 v24, v24, v25, v26
    v_or_b32 v24, v24, v27
    v_cmp_ne_u32 vcc, 0, v24
    s_cbranch_vccnz Lq_12
Lq_14:
    s_waitcnt lgkmcnt(4)
    ds_write2_b32 v126, v32, v34 offset0:0 offset1:1
    ds_write2_b32 v126, v36, v38 offset0:160 offset1:161
    ds_read_b128 v[64:67], v9 offset:0
    ds_read_b128 v[68:71], v9 offset:64
    ds_read_b128 v[72:75], v9 offset:128
    ds_read_b128 v[76:79], v9 offset:192
    s_waitcnt lgkmcnt(0)
    v_mfma_f32_16x16x32_bf16 v[32:35], v[64:67], a[0:3], 0
    v_mfma_f32_16x16x32_bf16 v[32:35], v[68:71], a[4:7], v[32:35]
    v_mfma_f32_16x16x32_bf16 v[32:35], v[72:75], a[8:11], v[32:35]
    v_mfma_f32_16x16x32_bf16 v[32:35], v[76:79], a[12:15], v[32:35]
    s_add_u32 m0, s89, 24576
    s_add_u32 s92, s71, 98304
    buffer_load_dwordx4 v112, s[48:51], s92 offen offset:0 nt lds
    v_mfma_f32_16x16x32_bf16 v[36:39], v[64:67], a[16:19], 0
    v_mfma_f32_16x16x32_bf16 v[36:39], v[68:71], a[20:23], v[36:39]
    v_mfma_f32_16x16x32_bf16 v[36:39], v[72:75], a[24:27], v[36:39]
    v_mfma_f32_16x16x32_bf16 v[36:39], v[76:79], a[28:31], v[36:39]
    buffer_load_dwordx4 v112, s[48:51], s92 offen offset:1024 nt lds
    v_mfma_f32_16x16x32_bf16 v[40:43], v[64:67], a[32:35], 0
    v_mfma_f32_16x16x32_bf16 v[40:43], v[68:71], a[36:39], v[40:43]
    v_mfma_f32_16x16x32_bf16 v[40:43], v[72:75], a[40:43], v[40:43]
    v_add_f32 v32, v32, v33
    v_add_f32 v34, v34, v35
    v_mfma_f32_16x16x32_bf16 v[40:43], v[76:79], a[44:47], v[40:43]
    v_add_f32 v32, v32, v34
    buffer_load_dwordx4 v113, s[48:51], s92 offen offset:2048 nt lds
    v_mfma_f32_16x16x32_bf16 v[44:47], v[64:67], a[48:51], 0
    v_mfma_f32_16x16x32_bf16 v[44:47], v[68:71], a[52:55], v[44:47]
    v_mfma_f32_16x16x32_bf16 v[44:47], v[72:75], a[56:59], v[44:47]
    v_add_f32 v36, v36, v37
    v_add_f32 v38, v38, v39
    v_mfma_f32_16x16x32_bf16 v[44:47], v[76:79], a[60:63], v[44:47]
    v_add_f32 v36, v36, v38
    buffer_load_dwordx4 v113, s[48:51], s92 offen offset:3072 nt lds
    v_mfma_f32_16x16x32_bf16 v[48:51], v[64:67], a[64:67], 0
    v_mfma_f32_16x16x32_bf16 v[48:51], v[68:71], a[68:71], v[48:51]
    v_mfma_f32_16x16x32_bf16 v[48:51], v[72:75], a[72:75], v[48:51]
    v_add_f32 v40, v40, v41
    v_add_f32 v42, v42, v43
    v_mfma_f32_16x16x32_bf16 v[48:51], v[76:79], a[76:79], v[48:51]
    v_add_f32 v40, v40, v42
    s_add_u32 m0, s89, 28672
    s_add_u32 s92, s71, 102400
    buffer_load_dwordx4 v112, s[48:51], s92 offen offset:0 nt lds
    v_mfma_f32_16x16x32_bf16 v[52:55], v[64:67], a[80:83], 0
    v_mfma_f32_16x16x32_bf16 v[52:55], v[68:71], a[84:87], v[52:55]
    v_mfma_f32_16x16x32_bf16 v[52:55], v[72:75], a[88:91], v[52:55]
    v_add_f32 v44, v44, v45
    v_add_f32 v46, v46, v47
    v_mfma_f32_16x16x32_bf16 v[52:55], v[76:79], a[92:95], v[52:55]
    v_add_f32 v44, v44, v46
    buffer_load_dwordx4 v112, s[48:51], s92 offen offset:1024 nt lds
    v_mfma_f32_16x16x32_bf16 v[56:59], v[64:67], a[96:99], 0
    v_mfma_f32_16x16x32_bf16 v[56:59], v[68:71], a[100:103], v[56:59]
    v_mfma_f32_16x16x32_bf16 v[56:59], v[72:75], a[104:107], v[56:59]
    v_add_f32 v48, v48, v49
    v_add_f32 v50, v50, v51
    v_mfma_f32_16x16x32_bf16 v[56:59], v[76:79], a[108:111], v[56:59]
    v_add_f32 v48, v48, v50
    v_cndmask_b32 v24, v32, v36, s[72:73]
    buffer_load_dwordx4 v113, s[48:51], s92 offen offset:2048 nt lds
    v_mfma_f32_16x16x32_bf16 v[60:63], v[64:67], a[112:115], 0
    v_mfma_f32_16x16x32_bf16 v[60:63], v[68:71], a[116:119], v[60:63]
    v_mfma_f32_16x16x32_bf16 v[60:63], v[72:75], a[120:123], v[60:63]
    v_cndmask_b32 v24, v24, v40, s[74:75]
    v_cndmask_b32 v24, v24, v44, s[76:77]
    v_mfma_f32_16x16x32_bf16 v[60:63], v[76:79], a[124:127], v[60:63]
    v_mul_f32 v24, s82, v24
    v_add_f32 v52, v52, v53
    buffer_load_dwordx4 v113, s[48:51], s92 offen offset:3072 nt lds
    v_add_f32 v54, v54, v55
    v_add_f32 v52, v52, v54
    v_add_f32 v56, v56, v57
    v_add_f32 v58, v58, v59
    v_add_f32 v56, v56, v58
    v_add_f32 v60, v60, v61
    v_add_f32 v62, v62, v63
    v_add_f32 v60, v60, v62
    v_cndmask_b32 v25, v48, v52, s[72:73]
    v_cndmask_b32 v25, v25, v56, s[74:75]
    v_cndmask_b32 v25, v25, v60, s[76:77]
    v_mul_f32 v25, s82, v25
    v_max_f32 v26, v24, v25
    s_nop 1
    v_max_f32_dpp v26, v26, v26 row_shr:1 row_mask:0xf bank_mask:0xf
    s_nop 1
    v_max_f32_dpp v26, v26, v26 row_shr:2 row_mask:0xf bank_mask:0xf
    s_nop 1
    v_max_f32_dpp v26, v26, v26 row_shr:4 row_mask:0xf bank_mask:0xf
    s_nop 1
    v_max_f32_dpp v26, v26, v26 row_shr:8 row_mask:0xf bank_mask:0xf
    s_nop 1
    v_max_f32_dpp v26, v26, v26 row_bcast:15 row_mask:0xa bank_mask:0xf
    s_nop 1
    v_max_f32_dpp v26, v26, v26 row_bcast:31 row_mask:0xc bank_mask:0xf
    s_nop 0
    v_readlane_b32 s87, v26, 63
    s_nop 1
    v_subrev_f32 v24, s87, v24
    v_subrev_f32 v25, s87, v25
    v_exp_f32 v24, v24
    v_exp_f32 v25, v25
    s_nop 0
    v_cvt_pk_bf16_f32 v26, v24, v25
    ds_write_b16 v6, v26
    ds_write_b16_d16_hi v6, v26 offset:128
    ds_read_b128 v[64:67], v3 offset:0
    ds_read_b128 v[68:71], v3 offset:64
    ds_read_b128 v[72:75], v3 offset:128
    ds_read_b128 v[76:79], v3 offset:192
    v_add_f32 v30, v24, v25
    s_nop 1
    v_add_f32_dpp v30, v30, v30 row_shr:1 row_mask:0xf bank_mask:0xf
    s_nop 1
    v_add_f32_dpp v30, v30, v30 row_shr:2 row_mask:0xf bank_mask:0xf
    s_nop 1
    v_add_f32_dpp v30, v30, v30 row_shr:4 row_mask:0xf bank_mask:0xf
    s_nop 1
    v_add_f32_dpp v30, v30, v30 row_shr:8 row_mask:0xf bank_mask:0xf
    s_nop 1
    v_add_f32_dpp v30, v30, v30 row_bcast:15 row_mask:0xa bank_mask:0xf
    s_nop 1
    v_add_f32_dpp v30, v30, v30 row_bcast:31 row_mask:0xc bank_mask:0xf
    s_nop 0
    v_readlane_b32 s88, v30, 63
    s_waitcnt vmcnt(26) lgkmcnt(0)
    ds_read_b64_tr_b16 v[128:129], v114 offset:0
    ds_read_b64_tr_b16 v[130:131], v114 offset:1024
    ds_read_b64_tr_b16 v[144:145], v115 offset:0
    ds_read_b64_tr_b16 v[146:147], v115 offset:1024
    ds_read_b64_tr_b16 v[160:161], v116 offset:0
    ds_read_b64_tr_b16 v[162:163], v116 offset:1024
    ds_read_b64_tr_b16 v[176:177], v117 offset:0
    ds_read_b64_tr_b16 v[178:179], v117 offset:1024
    ds_read_b64_tr_b16 v[192:193], v118 offset:0
    ds_read_b64_tr_b16 v[194:195], v118 offset:1024
    ds_read_b64_tr_b16 v[208:209], v119 offset:0
    ds_read_b64_tr_b16 v[210:211], v119 offset:1024
    s_waitcnt lgkmcnt(10)
    v_mfma_f32_16x16x32_bf16 v[32:35], v[64:67], v[128:131], 0
    ds_read_b64_tr_b16 v[224:225], v120 offset:0
    ds_read_b64_tr_b16 v[226:227], v120 offset:1024
    s_waitcnt lgkmcnt(10)
    v_mfma_f32_16x16x32_bf16 v[36:39], v[64:67], v[144:147], 0
    ds_read_b64_tr_b16 v[240:241], v121 offset:0
    ds_read_b64_tr_b16 v[242:243], v121 offset:1024
    s_waitcnt lgkmcnt(10)
    v_mfma_f32_16x16x32_bf16 v[40:43], v[64:67], v[160:163], 0
    s_waitcnt lgkmcnt(8)
    v_mfma_f32_16x16x32_bf16 v[44:47], v[64:67], v[176:179], 0
    s_waitcnt lgkmcnt(6)
    v_mfma_f32_16x16x32_bf16 v[48:51], v[64:67], v[192:195], 0
    s_waitcnt lgkmcnt(4)
    v_mfma_f32_16x16x32_bf16 v[52:55], v[64:67], v[208:211], 0
    s_waitcnt lgkmcnt(2)
    v_mfma_f32_16x16x32_bf16 v[56:59], v[64:67], v[224:227], 0
    s_waitcnt lgkmcnt(0)
    v_mfma_f32_16x16x32_bf16 v[60:63], v[64:67], v[240:243], 0
    v_and_b32 v83, 0xffff0000, v81
    v_lshlrev_b32 v82, 16, v81
    v_and_b32 v81, 0xffff0000, v80
    v_lshlrev_b32 v80, 16, v80
    v_and_b32 v87, 0xffff0000, v85
    v_lshlrev_b32 v86, 16, v85
    v_and_b32 v85, 0xffff0000, v84
    v_lshlrev_b32 v84, 16, v84
    s_waitcnt vmcnt(16)
    ds_read_b64_tr_b16 v[132:133], v114 offset:8192
    ds_read_b64_tr_b16 v[134:135], v114 offset:9216
    ds_read_b64_tr_b16 v[148:149], v115 offset:8192
    ds_read_b64_tr_b16 v[150:151], v115 offset:9216
    ds_read_b64_tr_b16 v[164:165], v116 offset:8192
    ds_read_b64_tr_b16 v[166:167], v116 offset:9216
    ds_read_b64_tr_b16 v[180:181], v117 offset:8192
    ds_read_b64_tr_b16 v[182:183], v117 offset:9216
    ds_read_b64_tr_b16 v[196:197], v118 offset:8192
    ds_read_b64_tr_b16 v[198:199], v118 offset:9216
    ds_read_b64_tr_b16 v[212:213], v119 offset:8192
    ds_read_b64_tr_b16 v[214:215], v119 offset:9216
    s_waitcnt lgkmcnt(10)
    v_mfma_f32_16x16x32_bf16 v[32:35], v[68:71], v[132:135], v[32:35]
    ds_read_b64_tr_b16 v[228:229], v120 offset:8192
    ds_read_b64_tr_b16 v[230:231], v120 offset:9216
    s_waitcnt lgkmcnt(10)
    v_mfma_f32_16x16x32_bf16 v[36:39], v[68:71], v[148:151], v[36:39]
    ds_read_b64_tr_b16 v[244:245], v121 offset:8192
    ds_read_b64_tr_b16 v[246:247], v121 offset:9216
    s_waitcnt lgkmcnt(10)
    v_mfma_f32_16x16x32_bf16 v[40:43], v[68:71], v[164:167], v[40:43]
    s_waitcnt lgkmcnt(8)
    v_mfma_f32_16x16x32_bf16 v[44:47], v[68:71], v[180:183], v[44:47]
    s_waitcnt lgkmcnt(6)
    v_mfma_f32_16x16x32_bf16 v[48:51], v[68:71], v[196:199], v[48:51]
    s_waitcnt lgkmcnt(4)
    v_mfma_f32_16x16x32_bf16 v[52:55], v[68:71], v[212:215], v[52:55]
    s_waitcnt lgkmcnt(2)
    v_mfma_f32_16x16x32_bf16 v[56:59], v[68:71], v[228:231], v[56:59]
    s_waitcnt lgkmcnt(0)
    v_mfma_f32_16x16x32_bf16 v[60:63], v[68:71], v[244:247], v[60:63]
    v_and_b32 v89, 7, v0
    v_lshlrev_b32 v89, 7, v89
    v_add_u32 v89, 0x192000, v89
    buffer_load_dword v90, v89, s[8:11], 0 offen sc1
    s_mov_b32 m0, 0x18000
    s_add_u32 s93, s42, 0
    buffer_load_dwordx4 v122, s[52:55], s93 offen nt lds
    s_mov_b32 m0, 0x18400
    s_add_u32 s93, s42, 8192
    buffer_load_dwordx4 v123, s[52:55], s93 offen nt lds
    s_mov_b32 m0, 0x18800
    s_add_u32 s93, s42, 16384
    buffer_load_dwordx4 v122, s[52:55], s93 offen nt lds
    s_mov_b32 m0, 0x18c00
    s_add_u32 s93, s42, 24576
    buffer_load_dwordx4 v123, s[52:55], s93 offen nt lds
    s_mov_b32 m0, 0x19000
    s_add_u32 s93, s42, 32768
    buffer_load_dwordx4 v122, s[52:55], s93 offen nt lds
    s_mov_b32 m0, 0x19400
    s_add_u32 s93, s42, 40960
    buffer_load_dwordx4 v123, s[52:55], s93 offen nt lds
    s_mov_b32 m0, 0x19800
    s_add_u32 s93, s42, 49152
    buffer_load_dwordx4 v122, s[52:55], s93 offen nt lds
    s_mov_b32 m0, 0x19c00
    s_add_u32 s93, s42, 57344
    buffer_load_dwordx4 v123, s[52:55], s93 offen nt lds
    s_mov_b32 m0, 0x1a000
    s_add_u32 s93, s42, 65536
    buffer_load_dwordx4 v122, s[52:55], s93 offen nt lds
    s_mov_b32 m0, 0x1a400
    s_add_u32 s93, s42, 73728
    buffer_load_dwordx4 v123, s[52:55], s93 offen nt lds
    s_mov_b32 m0, 0x1a800
    s_add_u32 s93, s42, 81920
    buffer_load_dwordx4 v122, s[52:55], s93 offen nt lds
    s_mov_b32 m0, 0x1ac00
    s_add_u32 s93, s42, 90112
    buffer_load_dwordx4 v123, s[52:55], s93 offen nt lds
    s_mov_b32 m0, 0x1b000
    s_add_u32 s93, s42, 98304
    buffer_load_dwordx4 v122, s[52:55], s93 offen nt lds
    s_mov_b32 m0, 0x1b400
    s_add_u32 s93, s42, 106496
    buffer_load_dwordx4 v123, s[52:55], s93 offen nt lds
    s_mov_b32 m0, 0x1b800
    s_add_u32 s93, s42, 114688
    buffer_load_dwordx4 v122, s[52:55], s93 offen nt lds
    s_mov_b32 m0, 0x1bc00
    s_add_u32 s93, s42, 122880
    buffer_load_dwordx4 v123, s[52:55], s93 offen nt lds
    s_cmp_eq_u32 s81, 0
    s_cbranch_scc1 L_gslow
L_gdone:
    v_mov_b32 v28, s81
    v_mov_b32 v29, 0x26000
    ds_write_b32 v29, v28 offset:32
    s_waitcnt lgkmcnt(0)
    s_waitcnt vmcnt(25)
    ds_read_b64_tr_b16 v[136:137], v114 offset:16384
    ds_read_b64_tr_b16 v[138:139], v114 offset:17408
    ds_read_b64_tr_b16 v[152:153], v115 offset:16384
    ds_read_b64_tr_b16 v[154:155], v115 offset:17408
    ds_read_b64_tr_b16 v[168:169], v116 offset:16384
    ds_read_b64_tr_b16 v[170:171], v116 offset:17408
    ds_read_b64_tr_b16 v[184:185], v117 offset:16384
    ds_read_b64_tr_b16 v[186:187], v117 offset:17408
    ds_read_b64_tr_b16 v[200:201], v118 offset:16384
    ds_read_b64_tr_b16 v[202:203], v118 offset:17408
    ds_read_b64_tr_b16 v[216:217], v119 offset:16384
    ds_read_b64_tr_b16 v[218:219], v119 offset:17408
    s_waitcnt lgkmcnt(10)
    v_mfma_f32_16x16x32_bf16 v[32:35], v[72:75], v[136:139], v[32:35]
    ds_read_b64_tr_b16 v[232:233], v120 offset:16384
    ds_read_b64_tr_b16 v[234:235], v120 offset:17408
    s_waitcnt lgkmcnt(10)
    v_mfma_f32_16x16x32_bf16 v[36:39], v[72:75], v[152:155], v[36:39]
    ds_read_b64_tr_b16 v[248:249], v121 offset:16384
    ds_read_b64_tr_b16 v[250:251], v121 offset:17408
    s_waitcnt lgkmcnt(10)
    v_mfma_f32_16x16x32_bf16 v[40:43], v[72:75], v[168:171], v[40:43]
    s_waitcnt lgkmcnt(8)
    v_mfma_f32_16x16x32_bf16 v[44:47], v[72:75], v[184:187], v[44:47]
    s_waitcnt lgkmcnt(6)
    v_mfma_f32_16x16x32_bf16 v[48:51], v[72:75], v[200:203], v[48:51]
    s_waitcnt lgkmcnt(4)
    v_mfma_f32_16x16x32_bf16 v[52:55], v[72:75], v[216:219], v[52:55]
    s_waitcnt lgkmcnt(2)
    v_mfma_f32_16x16x32_bf16 v[56:59], v[72:75], v[232:235], v[56:59]
    s_waitcnt lgkmcnt(0)
    v_mfma_f32_16x16x32_bf16 v[60:63], v[72:75], v[248:251], v[60:63]
    s_waitcnt vmcnt(17)
    ds_read_b64_tr_b16 v[140:141], v114 offset:24576
    ds_read_b64_tr_b16 v[142:143], v114 offset:25600
    ds_read_b64_tr_b16 v[156:157], v115 offset:24576
    ds_read_b64_tr_b16 v[158:159], v115 offset:25600
    ds_read_b64_tr_b16 v[172:173], v116 offset:24576
    ds_read_b64_tr_b16 v[174:175], v116 offset:25600
    ds_read_b64_tr_b16 v[188:189], v117 offset:24576
    ds_read_b64_tr_b16 v[190:191], v117 offset:25600
    ds_read_b64_tr_b16 v[204:205], v118 offset:24576
    ds_read_b64_tr_b16 v[206:207], v118 offset:25600
    ds_read_b64_tr_b16 v[220:221], v119 offset:24576
    ds_read_b64_tr_b16 v[222:223], v119 offset:25600
    s_waitcnt lgkmcnt(10)
    v_mfma_f32_16x16x32_bf16 v[32:35], v[76:79], v[140:143], v[32:35]
    ds_read_b64_tr_b16 v[236:237], v120 offset:24576
    ds_read_b64_tr_b16 v[238:239], v120 offset:25600
    s_waitcnt lgkmcnt(10)
    v_mfma_f32_16x16x32_bf16 v[36:39], v[76:79], v[156:159], v[36:39]
    ds_read_b64_tr_b16 v[252:253], v121 offset:24576
    ds_read_b64_tr_b16 v[254:255], v121 offset:25600
    s_waitcnt lgkmcnt(10)
    v_mfma_f32_16x16x32_bf16 v[40:43], v[76:79], v[172:175], v[40:43]
    s_waitcnt lgkmcnt(8)
    v_mfma_f32_16x16x32_bf16 v[44:47], v[76:79], v[188:191], v[44:47]
    s_waitcnt lgkmcnt(6)
    v_mfma_f32_16x16x32_bf16 v[48:51], v[76:79], v[204:207], v[48:51]
    s_waitcnt lgkmcnt(4)
    v_mfma_f32_16x16x32_bf16 v[52:55], v[76:79], v[220:223], v[52:55]
    s_waitcnt lgkmcnt(2)
    v_mfma_f32_16x16x32_bf16 v[56:59], v[76:79], v[236:239], v[56:59]
    s_waitcnt lgkmcnt(0)
    v_mfma_f32_16x16x32_bf16 v[60:63], v[76:79], v[252:255], v[60:63]
    v_add_u32 v91, 1152, v22
    v_add_u32 v121, 0x1e900, v1
    v_and_b32 v126, 1, v0
    v_mul_u32_u24 v126, 0xaaaa, v126
    v_add_u32 v126, 0x4444, v126
    s_mov_b32 s92, 0x00010001
    s_mov_b32 s93, 0x00010001
    v_mov_b32 v26, s87
    v_mov_b32 v27, s88
    ds_write2_b32 v8, v26, v27 offset0:0 offset1:4
    v_cndmask_b32 v24, v32, v36, s[72:73]
    v_cndmask_b32 v24, v24, v40, s[74:75]
    v_cndmask_b32 v24, v24, v44, s[76:77]
    v_cndmask_b32 v25, v48, v52, s[72:73]
    v_cndmask_b32 v25, v25, v56, s[74:75]
    v_cndmask_b32 v25, v25, v60, s[76:77]
    ds_write2st64_b32 v7, v24, v25 offset0:0 offset1:1
    s_waitcnt lgkmcnt(0)
    s_barrier
L_loopB:
    v_mov_b32 v31, 0x26000
    ds_read_b128 v[72:75], v31
    ds_read_b128 v[76:79], v31 offset:16
    ds_read2st64_b64 v[64:67], v18 offset0:0 offset1:1
    ds_read2st64_b64 v[68:71], v18 offset0:2 offset1:3
    v_lshlrev_b32 v30, 5, v0
    s_waitcnt lgkmcnt(3)
    v_max_f32 v24, v72, v73
    v_max3_f32 v24, v24, v74, v75
    v_sub_f32 v72, v72, v24
    v_sub_f32 v73, v73, v24
    v_sub_f32 v74, v74, v24
    v_sub_f32 v75, v75, v24
    v_exp_f32 v72, v72
    v_exp_f32 v73, v73
    v_exp_f32 v74, v74
    v_exp_f32 v75, v75
    s_waitcnt lgkmcnt(0)
    v_mul_f32 v25, v72, v64
    v_mul_f32 v26, v72, v65
    v_fmac_f32 v25, v73, v66
    v_fmac_f32 v26, v73, v67
    v_fmac_f32 v25, v74, v68
    v_fmac_f32 v26, v74, v69
    v_fmac_f32 v25, v75, v70
    v_fmac_f32 v26, v75, v71
    v_cvt_pk_bf16_f32 v25, v25, v26
    v_mul_f32 v27, v72, v76
    v_fmac_f32 v27, v73, v77
    v_fmac_f32 v27, v74, v78
    v_fmac_f32 v27, v75, v79
    v_min_u32 v25, -2, v25
    s_mov_b64 vcc, 2
    v_cndmask_b32 v24, v24, v27, vcc
    v_min_u32 v24, -2, v24
    s_cmp_eq_u32 s81, 0
    s_cbranch_scc1 Lslow_15
    buffer_store_dword v25, v19, s[8:11], s60 offen
    s_mov_b64 exec, 3
    buffer_store_dword v24, v30, s[8:11], s61 offen
    s_mov_b64 exec, -1
Ljoin_16:
    v_mov_b32 v100, 0
    v_mov_b32 v101, 0
    v_mov_b32 v102, 0
    v_mov_b32 v103, 0
    buffer_load_dwordx4 v[92:95], v1, s[8:11], s62 offen offset:0 sc1
    buffer_load_dwordx4 v[96:99], v1, s[8:11], s62 offen offset:1024 sc1
    s_mov_b64 exec, 15
    buffer_load_dwordx4 v[100:103], v1, s[8:11], s63 offen sc1
    s_mov_b64 exec, -1
    s_cmp_eq_u32 s80, 1
    s_cbranch_scc1 L_wodone
    v_xor_b32 v24, 0x18000, v127
    v_xor_b32 v25, 0x18020, v127
    v_xor_b32 v26, 0x18040, v127
    v_xor_b32 v27, 0x18060, v127
    s_waitcnt vmcnt(5)
    ds_read_b64_tr_b16 a[128:129], v24 offset:0
    ds_read_b64_tr_b16 a[130:131], v24 offset:512
    ds_read_b64_tr_b16 a[132:133], v24 offset:4096
    ds_read_b64_tr_b16 a[134:135], v24 offset:4608
    ds_read_b64_tr_b16 a[136:137], v24 offset:8192
    ds_read_b64_tr_b16 a[138:139], v24 offset:8704
    ds_read_b64_tr_b16 a[140:141], v24 offset:12288
    ds_read_b64_tr_b16 a[142:143], v24 offset:12800
    s_waitcnt lgkmcnt(10)
    ds_read_b64_tr_b16 a[144:145], v25 offset:0
    ds_read_b64_tr_b16 a[146:147], v25 offset:512
    ds_read_b64_tr_b16 a[148:149], v25 offset:4096
    ds_read_b64_tr_b16 a[150:151], v25 offset:4608
    s_waitcnt lgkmcnt(10)
    ds_read_b64_tr_b16 a[152:153], v25 offset:8192
    ds_read_b64_tr_b16 a[154:155], v25 offset:8704
    ds_read_b64_tr_b16 a[156:157], v25 offset:12288
    ds_read_b64_tr_b16 a[158:159], v25 offset:12800
    s_waitcnt lgkmcnt(10)
    ds_read_b64_tr_b16 a[160:161], v26 offset:0
    ds_read_b64_tr_b16 a[162:163], v26 offset:512
    ds_read_b64_tr_b16 a[164:165], v26 offset:4096
    ds_read_b64_tr_b16 a[166:167], v26 offset:4608
    s_waitcnt lgkmcnt(10)
    ds_read_b64_tr_b16 a[168:169], v26 offset:8192
    ds_read_b64_tr_b16 a[170:171], v26 offset:8704
    ds_read_b64_tr_b16 a[172:173], v26 offset:12288
    ds_read_b64_tr_b16 a[174:175], v26 offset:12800
    s_waitcnt lgkmcnt(10)
    ds_read_b64_tr_b16 a[176:177], v27 offset:0
    ds_read_b64_tr_b16 a[178:179], v27 offset:512
    ds_read_b64_tr_b16 a[180:181], v27 offset:4096
    ds_read_b64_tr_b16 a[182:183], v27 offset:4608
    s_waitcnt lgkmcnt(10)
    ds_read_b64_tr_b16 a[184:185], v27 offset:8192
    ds_read_b64_tr_b16 a[186:187], v27 offset:8704
    ds_read_b64_tr_b16 a[188:189], v27 offset:12288
    ds_read_b64_tr_b16 a[190:191], v27 offset:12800
    v_xor_b32 v28, s56, v90
    v_cmp_lt_u32 vcc, 7, v28
    s_cbranch_vccnz L_fslow
L_fdone:
    s_waitcnt lgkmcnt(0)
L_wodone:
    v_mov_b32 v32, 0
    v_mov_b32 v33, 0
    v_mov_b32 v34, 0
    v_mov_b32 v35, 0
    v_mov_b32 v36, 0
    v_mov_b32 v37, 0
    v_mov_b32 v38, 0
    v_mov_b32 v39, 0
    v_mov_b32 v40, 0
    v_mov_b32 v41, 0
    v_mov_b32 v42, 0
    v_mov_b32 v43, 0
    v_mov_b32 v44, 0
    v_mov_b32 v45, 0
    v_mov_b32 v46, 0
    v_mov_b32 v47, 0
Lpoll_17:
    buffer_load_dwordx4 v[92:95], v1, s[8:11], s62 offen offset:0 sc1
    buffer_load_dwordx4 v[96:99], v1, s[8:11], s62 offen offset:1024 sc1
    s_mov_b64 exec, 15
    buffer_load_dwordx4 v[100:103], v1, s[8:11], s63 offen sc1
    s_mov_b64 exec, -1
    s_add_u32 s84, s84, 1
    s_cmp_gt_u32 s84, 400000
    s_waitcnt vmcnt(3)
    s_cbranch_scc1 Lpout_18
    v_max_u32 v31, v92, v93
    v_max3_u32 v31, v31, v94, v95
    v_max3_u32 v31, v31, v96, v97
    v_max3_u32 v31, v31, v98, v99
    v_max3_u32 v31, v31, v100, v101
    v_max3_u32 v31, v31, v102, v103
    v_cmp_eq_u32 vcc, -1, v31
    s_cbranch_vccnz Lpoll_17
Lpout_18:
    ds_write2_b32 v22, v92, v94 offset0:0 offset1:1
    ds_write2_b32 v22, v93, v95 offset0:36 offset1:37
    ds_write2_b32 v91, v96, v98 offset0:0 offset1:1
    ds_write2_b32 v91, v97, v99 offset0:36 offset1:37
    s_mov_b64 exec, 15
    ds_write_b128 v121, v[100:103]
    s_mov_b64 exec, -1
    ds_read_b128 v[64:67], v14 offset:0
    ds_read_b128 v[68:71], v14 offset:64
    ds_read_b128 v[52:55], v15
    ds_read_b128 v[56:59], v15 offset:16
    ds_read2_b64 v[60:63], v16 offset0:0 offset1:4
    s_waitcnt lgkmcnt(4)
    v_smfmac_f32_16x16x64_bf16 v[32:35], v[64:67], a[128:135], v126
    s_waitcnt lgkmcnt(3)
    v_smfmac_f32_16x16x64_bf16 v[32:35], v[68:71], a[136:143], v126
    s_waitcnt lgkmcnt(0)
    v_smfmac_f32_16x16x64_bf16 v[36:39], v[64:67], a[144:151], v126
    v_max3_f32 v24, v52, v53, v54
    v_max3_f32 v25, v55, v56, v57
    v_smfmac_f32_16x16x64_bf16 v[36:39], v[68:71], a[152:159], v126
    v_max3_f32 v24, v24, v58, v59
    v_max_f32 v24, v24, v25
    v_smfmac_f32_16x16x64_bf16 v[40:43], v[64:67], a[160:167], v126
    v_sub_f32 v48, v60, v24
    v_sub_f32 v49, v61, v24
    v_smfmac_f32_16x16x64_bf16 v[40:43], v[68:71], a[168:175], v126
    v_exp_f32 v48, v48
    v_exp_f32 v49, v49
    v_smfmac_f32_16x16x64_bf16 v[44:47], v[64:67], a[176:183], v126
    v_add_f32 v32, v32, v33
    v_mul_f32 v25, v48, v62
    v_smfmac_f32_16x16x64_bf16 v[44:47], v[68:71], a[184:191], v126
    v_fmac_f32 v25, v49, v63
    v_add_f32 v34, v34, v35
    v_mov_b32 v24, v25
    v_mul_f32 v26, v48, v32
    v_fmac_f32 v26, v49, v34
    v_permlane32_swap_b32 v24, v25
    v_add_f32 v25, v24, v25
    v_mov_b32 v24, v25
    v_add_f32 v36, v36, v37
    v_add_f32 v38, v38, v39
    v_mul_f32 v27, v48, v36
    v_fmac_f32 v27, v49, v38
    v_permlane16_swap_b32 v24, v25
    v_add_f32 v25, v24, v25
    v_rcp_f32 v25, v25
    v_add_f32 v40, v40, v41
    v_add_f32 v42, v42, v43
    v_mul_f32 v28, v48, v40
    v_fmac_f32 v28, v49, v42
    v_add_f32 v44, v44, v45
    v_add_f32 v46, v46, v47
    v_permlane32_swap_b32 v26, v28
    v_mul_f32 v29, v48, v44
    v_fmac_f32 v29, v49, v46
    v_add_f32 v26, v26, v28
    s_nop 0
    v_permlane32_swap_b32 v27, v29
    v_add_f32 v27, v27, v29
    s_nop 1
    v_permlane16_swap_b32 v26, v27
    v_add_f32 v26, v26, v27
    v_mul_f32 v26, v26, v25
    v_min_u32 v26, -2, v26
    s_waitcnt vmcnt(0)
    buffer_store_dword v26, v19, s[8:11], s64 offen sc1
    s_cmp_eq_u32 s80, 1
    s_cbranch_scc1 L_csdone
    s_barrier
    v_lshlrev_b32 v30, 3, v0
    v_add_u32 v29, 0x10000, v30
    ds_read_b64_tr_b16 a[192:193], v30 offset:4096
    ds_read_b64_tr_b16 a[194:195], v30 offset:4608
    ds_read_b64_tr_b16 a[196:197], v30 offset:5120
    ds_read_b64_tr_b16 a[198:199], v30 offset:5632
    ds_read_b64_tr_b16 a[200:201], v30 offset:36864
    ds_read_b64_tr_b16 a[202:203], v30 offset:37376
    ds_read_b64_tr_b16 a[204:205], v30 offset:37888
    ds_read_b64_tr_b16 a[206:207], v30 offset:38400
    s_waitcnt lgkmcnt(10)
    ds_read_b64_tr_b16 a[208:209], v29 offset:4096
    ds_read_b64_tr_b16 a[210:211], v29 offset:4608
    ds_read_b64_tr_b16 a[212:213], v29 offset:5120
    ds_read_b64_tr_b16 a[214:215], v29 offset:5632
    s_mov_b32 s58, 0x55555555
    s_mov_b32 s59, 0x55555555
    v_lshrrev_b32 v88, 1, v0
    v_lshlrev_b32 v88, 8, v88
    v_and_b32 v24, 1, v0
    v_lshl_add_u32 v88, v24, 2, v88
    s_lshl_b32 s57, s5, 3
    s_add_u32 s57, s57, s67
    s_waitcnt lgkmcnt(0)
    s_branch L_cs2
L_csdone:
L_cs2:
    v_mov_b32 v30, s83
    s_add_u32 s88, s65, 4096
    s_waitcnt vmcnt(0)
Lpoll_19:
    buffer_load_dwordx4 v[112:115], v17, s[8:11], s65 offen sc1
    buffer_load_dwordx4 v[116:119], v17, s[8:11], s88 offen sc1
    s_add_u32 s84, s84, 1
    s_cmp_gt_u32 s84, 400000
    s_waitcnt vmcnt(0)
    s_cbranch_scc1 Lpout_20
    v_max_u32 v31, v112, v113
    v_max3_u32 v31, v31, v114, v115
    v_max3_u32 v31, v31, v116, v117
    v_max3_u32 v31, v31, v118, v119
    v_cmp_eq_u32 vcc, -1, v31
    s_cbranch_vccnz Lpoll_19
Lpout_20:
    v_add_f32 v64, v112, v116
    v_add_f32 v65, v113, v117
    v_add_f32 v66, v114, v118
    v_add_f32 v67, v115, v119
    v_add_f32_dpp v64, v64, v64 row_ror:8 row_mask:0xf bank_mask:0xf
    v_add_f32_dpp v65, v65, v65 row_ror:8 row_mask:0xf bank_mask:0xf
    v_add_f32_dpp v66, v66, v66 row_ror:8 row_mask:0xf bank_mask:0xf
    v_add_f32_dpp v67, v67, v67 row_ror:8 row_mask:0xf bank_mask:0xf
    v_add_f32_dpp v64, v64, v64 row_ror:4 row_mask:0xf bank_mask:0xf
    v_add_f32_dpp v65, v65, v65 row_ror:4 row_mask:0xf bank_mask:0xf
    v_add_f32_dpp v66, v66, v66 row_ror:4 row_mask:0xf bank_mask:0xf
    v_add_f32_dpp v67, v67, v67 row_ror:4 row_mask:0xf bank_mask:0xf
    v_add_f32_dpp v64, v64, v64 row_ror:2 row_mask:0xf bank_mask:0xf
    v_add_f32_dpp v65, v65, v65 row_ror:2 row_mask:0xf bank_mask:0xf
    v_add_f32_dpp v66, v66, v66 row_ror:2 row_mask:0xf bank_mask:0xf
    v_add_f32_dpp v67, v67, v67 row_ror:2 row_mask:0xf bank_mask:0xf
    v_add_f32_dpp v64, v64, v64 row_ror:1 row_mask:0xf bank_mask:0xf
    v_add_f32_dpp v65, v65, v65 row_ror:1 row_mask:0xf bank_mask:0xf
    v_add_f32_dpp v66, v66, v66 row_ror:1 row_mask:0xf bank_mask:0xf
    v_add_f32_dpp v67, v67, v67 row_ror:1 row_mask:0xf bank_mask:0xf
    v_add_f32 v64, v80, v64
    v_add_f32 v65, v81, v65
    v_add_f32 v66, v82, v66
    v_add_f32 v67, v83, v67
    v_cvt_pk_bf16_f32 v72, v64, v65
    v_cvt_pk_bf16_f32 v73, v66, v67
    v_cndmask_b32 v64, 0, v72, s[58:59]
    v_cndmask_b32 v65, 0, v73, s[58:59]
    v_cndmask_b32 v66, v72, 0, s[58:59]
    v_cndmask_b32 v67, v73, 0, s[58:59]
    v_cndmask_b32 v74, v72, v30, s[58:59]
    v_cndmask_b32 v75, v73, v30, s[58:59]
    v_mfma_f32_16x16x32_bf16 v[32:35], v[64:67], a[192:195], 0
    s_add_u32 s85, s90, 8192
    v_mfma_f32_16x16x32_bf16 v[36:39], v[64:67], a[196:199], 0
    s_add_u32 s86, s90, 16384
    v_mfma_f32_16x16x16_bf16 v[76:79], v[72:73], v[74:75], 0
    s_cmp_eq_u32 s81, 0
    s_cbranch_scc1 Lslow_21
    v_mfma_f32_16x16x32_bf16 v[40:43], v[64:67], a[200:203], 0
    v_mfma_f32_16x16x32_bf16 v[44:47], v[64:67], a[204:207], 0
    v_mfma_f32_16x16x32_bf16 v[48:51], v[64:67], a[208:211], 0
    v_mfma_f32_16x16x32_bf16 v[52:55], v[64:67], a[212:215], 0
    v_cndmask_b32 v24, v32, v33, s[72:73]
    v_cndmask_b32 v24, v24, v36, s[74:75]
    v_cndmask_b32 v24, v24, v37, s[76:77]
    v_min_u32 v24, -2, v24
    buffer_store_dword v24, v11, s[8:11], s90 offen
    v_min_u32 v27, -2, v76
    s_mov_b64 exec, 0xffffff
    buffer_store_dword v27, v88, s[8:11], s57 offen offset:1024
    s_mov_b64 exec, -1
    v_cndmask_b32 v25, v40, v41, s[72:73]
    v_cndmask_b32 v25, v25, v44, s[74:75]
    v_cndmask_b32 v25, v25, v45, s[76:77]
    v_min_u32 v25, -2, v25
    buffer_store_dword v25, v11, s[8:11], s85 offen
    v_cndmask_b32 v26, v48, v49, s[72:73]
    v_cndmask_b32 v26, v26, v52, s[74:75]
    v_cndmask_b32 v26, v26, v53, s[76:77]
    v_min_u32 v26, -2, v26
    buffer_store_dword v26, v11, s[8:11], s86 offen
Ljoin_22:
    s_barrier
    s_lshl_b32 s85, s3, 5
    v_and_b32 v27, 0x800, v127
    v_xor_b32 v30, v27, v127
    v_lshl_add_u32 v30, v27, 4, v30
    v_xor_b32 v30, s85, v30
    ds_read_b64_tr_b16 a[232:233], v30 offset:0
    ds_read_b64_tr_b16 a[234:235], v30 offset:512
    s_add_u32 s85, s85, 0x10000
    v_lshrrev_b32 v30, 2, v0
    v_lshlrev_b32 v30, 7, v30
    v_and_b32 v27, 3, v0
    v_lshl_add_u32 v30, v27, 3, v30
    v_bfe_u32 v27, v0, 3, 1
    v_lshl_add_u32 v30, v27, 5, v30
    v_lshrrev_b32 v27, 5, v0
    v_lshl_add_u32 v30, v27, 6, v30
    v_xor_b32 v30, s85, v30
    ds_read_b64_tr_b16 a[236:237], v30 offset:0
    v_lshlrev_b32 v80, 16, v72
    v_and_b32 v81, 0xffff0000, v72
    v_lshlrev_b32 v82, 16, v73
    v_and_b32 v83, 0xffff0000, v73
    v_add_f32 v80, v80, v84
    v_add_f32 v81, v81, v85
    v_add_f32 v82, v82, v86
    v_add_f32 v83, v83, v87
    s_add_u32 s87, s65, 0x10000
    s_barrier
    ds_read_b128 v[64:67], v12
    ds_read_b64 v[68:69], v13
    s_waitcnt lgkmcnt(0)
    v_mfma_f32_16x16x32_bf16 v[32:35], v[64:67], a[232:235], 0
    v_mfma_f32_16x16x16_bf16 v[36:39], v[68:69], a[236:237], 0
    s_nop 7
    v_add_f32 v24, v32, v36
    v_min_u32 v24, -2, v24
    s_mov_b64 exec, 0xffff
    buffer_store_dword v24, v11, s[8:11], s69 offen sc1
    s_mov_b64 exec, -1
    s_lshl_b32 s85, s80, 3
    s_add_u32 s85, s85, s4
    s_cmp_gt_u32 s85, 8
    s_cbranch_scc1 L_endB
    s_cmp_eq_u32 s80, 1
    s_cbranch_scc1 L_last
    v_xor_b32 v24, 0x20000, v127
    v_xor_b32 v25, 0x20020, v127
    v_xor_b32 v26, 0x20040, v127
    ds_read_b64_tr_b16 a[238:239], v24 offset:0
    ds_read_b64_tr_b16 a[240:241], v24 offset:512
    ds_read_b64_tr_b16 a[242:243], v24 offset:4096
    ds_read_b64_tr_b16 a[244:245], v24 offset:4608
    ds_read_b64_tr_b16 a[246:247], v24 offset:8192
    ds_read_b64_tr_b16 a[248:249], v24 offset:8704
    ds_read_b64_tr_b16 a[250:251], v24 offset:12288
    ds_read_b64_tr_b16 a[252:253], v24 offset:12800
    s_waitcnt lgkmcnt(10)
    ds_read_b64_tr_b16 v[48:49], v25 offset:0
    ds_read_b64_tr_b16 v[50:51], v25 offset:512
    ds_read_b64_tr_b16 v[52:53], v25 offset:4096
    ds_read_b64_tr_b16 v[54:55], v25 offset:4608
    s_waitcnt lgkmcnt(10)
    ds_read_b64_tr_b16 v[56:57], v25 offset:8192
    ds_read_b64_tr_b16 v[58:59], v25 offset:8704
    ds_read_b64_tr_b16 v[60:61], v25 offset:12288
    ds_read_b64_tr_b16 v[62:63], v25 offset:12800
    s_waitcnt lgkmcnt(10)
    ds_read_b64_tr_b16 v[92:93], v26 offset:0
    ds_read_b64_tr_b16 v[94:95], v26 offset:512
    ds_read_b64_tr_b16 v[96:97], v26 offset:4096
    ds_read_b64_tr_b16 v[98:99], v26 offset:4608
    s_waitcnt lgkmcnt(10)
    ds_read_b64_tr_b16 v[100:101], v26 offset:8192
    ds_read_b64_tr_b16 v[102:103], v26 offset:8704
    ds_read_b64_tr_b16 v[104:105], v26 offset:12288
    ds_read_b64_tr_b16 v[106:107], v26 offset:12800
    v_mov_b32 v68, s83
    v_mov_b32 v69, s83
    v_mov_b32 v70, s83
    v_mov_b32 v71, s83
    ds_write_b128 v2, v[68:71] offset:1024
    s_add_u32 s88, s87, 4096
    s_waitcnt vmcnt(0)
Lpoll_23:
    buffer_load_dwordx4 v[112:115], v17, s[8:11], s87 offen sc1
    buffer_load_dwordx4 v[116:119], v17, s[8:11], s88 offen sc1
    s_add_u32 s84, s84, 1
    s_cmp_gt_u32 s84, 400000
    s_waitcnt vmcnt(0)
    s_cbranch_scc1 Lpout_24
    v_max_u32 v31, v112, v113
    v_max3_u32 v31, v31, v114, v115
    v_max3_u32 v31, v31, v116, v117
    v_max3_u32 v31, v31, v118, v119
    v_cmp_eq_u32 vcc, -1, v31
    s_cbranch_vccnz Lpoll_23
Lpout_24:
    v_add_f32 v64, v112, v116
    v_add_f32 v65, v113, v117
    v_add_f32 v66, v114, v118
    v_add_f32 v67, v115, v119
    v_add_f32_dpp v64, v64, v64 row_ror:8 row_mask:0xf bank_mask:0xf
    v_add_f32_dpp v65, v65, v65 row_ror:8 row_mask:0xf bank_mask:0xf
    v_add_f32_dpp v66, v66, v66 row_ror:8 row_mask:0xf bank_mask:0xf
    v_add_f32_dpp v67, v67, v67 row_ror:8 row_mask:0xf bank_mask:0xf
    v_add_f32_dpp v64, v64, v64 row_ror:4 row_mask:0xf bank_mask:0xf
    v_add_f32_dpp v65, v65, v65 row_ror:4 row_mask:0xf bank_mask:0xf
    v_add_f32_dpp v66, v66, v66 row_ror:4 row_mask:0xf bank_mask:0xf
    v_add_f32_dpp v67, v67, v67 row_ror:4 row_mask:0xf bank_mask:0xf
    v_add_f32_dpp v64, v64, v64 row_ror:2 row_mask:0xf bank_mask:0xf
    v_add_f32_dpp v65, v65, v65 row_ror:2 row_mask:0xf bank_mask:0xf
    v_add_f32_dpp v66, v66, v66 row_ror:2 row_mask:0xf bank_mask:0xf
    v_add_f32_dpp v67, v67, v67 row_ror:2 row_mask:0xf bank_mask:0xf
    v_add_f32_dpp v64, v64, v64 row_ror:1 row_mask:0xf bank_mask:0xf
    v_add_f32_dpp v65, v65, v65 row_ror:1 row_mask:0xf bank_mask:0xf
    v_add_f32_dpp v66, v66, v66 row_ror:1 row_mask:0xf bank_mask:0xf
    v_add_f32_dpp v67, v67, v67 row_ror:1 row_mask:0xf bank_mask:0xf
    v_add_f32 v64, v80, v64
    v_add_f32 v65, v81, v65
    v_add_f32 v66, v82, v66
    v_add_f32 v67, v83, v67
    v_cvt_pk_bf16_f32 v72, v64, v65
    v_cvt_pk_bf16_f32 v73, v66, v67
    v_min_u32 v74, -2, v72
    v_min_u32 v75, -2, v73
    s_mov_b64 exec, s[92:93]
    s_cmp_eq_u32 s81, 0
    s_cbranch_scc1 Lslow_25
    buffer_store_dwordx2 v[74:75], v20, s[8:11], s66 offen offset:0
Ljoin_26:
    s_mov_b64 exec, -1
    buffer_load_dwordx4 v[108:111], v1, s[8:11], s67 offen sc1
    v_lshlrev_b32 v80, 16, v72
    v_and_b32 v81, 0xffff0000, v72
    v_lshlrev_b32 v82, 16, v73
    v_and_b32 v83, 0xffff0000, v73
    s_lshl_b32 s85, s3, 11
    s_add_u32 s85, s85, 0x24000
    v_and_b32 v24, 1, v0
    v_mul_u32_u24 v126, 0xaaaa, v24
    v_add_u32 v126, 0x4444, v126
    v_mul_u32_u24 v124, 160, v24
    v_lshrrev_b32 v25, 4, v0
    v_lshl_add_u32 v124, v25, 4, v124
    v_add_u32 v124, s85, v124
    v_bfe_u32 v25, v0, 1, 1
    v_mul_u32_u24 v123, 160, v25
    v_lshl_add_u32 v123, v24, 1, v123
    v_and_b32 v25, 0x3c, v0
    v_add3_u32 v123, v123, v25, s85
    buffer_load_dwordx4 v[108:111], v1, s[8:11], s67 offen sc1
Lpoll_27:
    buffer_load_dwordx4 v[108:111], v1, s[8:11], s67 offen sc1
    s_add_u32 s84, s84, 1
    s_cmp_gt_u32 s84, 400000
    s_waitcnt vmcnt(2)
    s_cbranch_scc1 Lpout_28
    v_max_u32 v31, v108, v109
    v_max3_u32 v31, v31, v110, v111
    v_cmp_eq_u32 vcc, -1, v31
    s_cbranch_vccnz Lpoll_27
Lpout_28:
    ds_write_b128 v2, v[108:111]
    ds_read_b128 v[64:67], v5 offset:0
    ds_read_b128 v[68:71], v5 offset:64
    ds_read_b128 v[72:75], v5 offset:128
    ds_read_b128 v[76:79], v5 offset:192
    v_dot2_f32_bf16 v25, v108, s83, 0
    v_dot2_f32_bf16 v26, v108, v108, 0
    v_dot2_f32_bf16 v25, v109, s83, v25
    v_dot2_f32_bf16 v26, v109, v109, v26
    v_dot2_f32_bf16 v25, v110, s83, v25
    v_dot2_f32_bf16 v26, v110, v110, v26
    v_dot2_f32_bf16 v25, v111, s83, v25
    v_dot2_f32_bf16 v26, v111, v111, v26
    v_mov_b32 v27, 0x3b000000
    s_nop 0
    v_add_f32_dpp v25, v25, v25 row_shr:1 row_mask:0xf bank_mask:0xf
    v_add_f32_dpp v26, v26, v26 row_shr:1 row_mask:0xf bank_mask:0xf
    s_nop 0
    v_add_f32_dpp v25, v25, v25 row_shr:2 row_mask:0xf bank_mask:0xf
    v_add_f32_dpp v26, v26, v26 row_shr:2 row_mask:0xf bank_mask:0xf
    s_waitcnt lgkmcnt(3)
    v_mfma_f32_16x16x32_bf16 v[32:35], v[64:67], a[238:241], 0
    v_add_f32_dpp v25, v25, v25 row_shr:4 row_mask:0xf bank_mask:0xf
    v_add_f32_dpp v26, v26, v26 row_shr:4 row_mask:0xf bank_mask:0xf
    v_mfma_f32_16x16x32_bf16 v[36:39], v[64:67], v[48:51], 0
    v_add_f32_dpp v25, v25, v25 row_shr:8 row_mask:0xf bank_mask:0xf
    v_add_f32_dpp v26, v26, v26 row_shr:8 row_mask:0xf bank_mask:0xf
    v_mfma_f32_16x16x32_bf16 v[40:43], v[64:67], v[92:95], 0
    v_add_f32_dpp v25, v25, v25 row_bcast:15 row_mask:0xa bank_mask:0xf
    v_add_f32_dpp v26, v26, v26 row_bcast:15 row_mask:0xa bank_mask:0xf
    v_mfma_f32_16x16x32_bf16 v[44:47], v[64:67], a[216:219], 0
    v_add_f32_dpp v25, v25, v25 row_bcast:31 row_mask:0xc bank_mask:0xf
    v_add_f32_dpp v26, v26, v26 row_bcast:31 row_mask:0xc bank_mask:0xf
    s_waitcnt lgkmcnt(2)
    v_mfma_f32_16x16x32_bf16 v[32:35], v[68:71], a[242:245], v[32:35]
    v_readlane_b32 s85, v25, 63
    v_readlane_b32 s86, v26, 63
    v_mfma_f32_16x16x32_bf16 v[36:39], v[68:71], v[52:55], v[36:39]
    v_mul_f32 v28, s85, v27
    v_mul_f32 v29, s86, v27
    v_mfma_f32_16x16x32_bf16 v[40:43], v[68:71], v[96:99], v[40:43]
    v_fma_f32 v29, -v28, v28, v29
    v_max_f32 v29, 0, v29
    v_mfma_f32_16x16x32_bf16 v[44:47], v[68:71], a[220:223], v[44:47]
    v_add_f32 v29, 0x3727c5ac, v29
    v_rsq_f32 v29, v29
    s_waitcnt lgkmcnt(1)
    v_mfma_f32_16x16x32_bf16 v[32:35], v[72:75], a[246:249], v[32:35]
    v_mfma_f32_16x16x32_bf16 v[36:39], v[72:75], v[56:59], v[36:39]
    v_mfma_f32_16x16x32_bf16 v[40:43], v[72:75], v[100:103], v[40:43]
    v_mfma_f32_16x16x32_bf16 v[44:47], v[72:75], a[224:227], v[44:47]
    s_waitcnt lgkmcnt(0)
    v_mfma_f32_16x16x32_bf16 v[32:35], v[76:79], a[250:253], v[32:35]
    v_mfma_f32_16x16x32_bf16 v[36:39], v[76:79], v[60:63], v[36:39]
    v_mfma_f32_16x16x32_bf16 v[40:43], v[76:79], v[104:107], v[40:43]
    v_mfma_f32_16x16x32_bf16 v[44:47], v[76:79], a[228:231], v[44:47]
    s_nop 5
    v_cndmask_b32 v24, v32, v36, s[72:73]
    v_cndmask_b32 v24, v24, v40, s[74:75]
    v_cndmask_b32 v24, v24, v44, s[76:77]
    v_cndmask_b32 v25, v33, v37, s[72:73]
    v_cndmask_b32 v25, v25, v41, s[74:75]
    v_cndmask_b32 v25, v25, v45, s[76:77]
    v_fma_f32 v24, -v28, v25, v24
    v_mul_f32 v24, v29, v24
    s_nop 1
    v_mov_b32_dpp v25, v24 quad_perm:[1,1,3,3] row_mask:0xf bank_mask:0xf
    v_cvt_pk_bf16_f32 v25, v24, v25
    v_min_u32 v25, -2, v25
    s_mov_b32 exec_lo, 0x55555555
    s_mov_b32 exec_hi, 0x55555555
    s_cmp_eq_u32 s81, 0
    s_cbranch_scc1 Lslow_29
    buffer_store_dword v25, v10, s[8:11], s68 offen
Ljoin_30:
    s_mov_b64 exec, -1
    buffer_load_dwordx4 v[92:95], v1, s[8:11], s70 offen sc1
    v_mov_b32 v32, 0
    v_mov_b32 v33, 0
    v_mov_b32 v34, 0
    v_mov_b32 v35, 0
    v_mov_b32 v36, 0
    v_mov_b32 v37, 0
    v_mov_b32 v38, 0
    v_mov_b32 v39, 0
    v_mov_b32 v40, 0
    v_mov_b32 v41, 0
    v_mov_b32 v42, 0
    v_mov_b32 v43, 0
    v_mov_b32 v44, 0
    v_mov_b32 v45, 0
    v_mov_b32 v46, 0
    v_mov_b32 v47, 0
    v_mov_b32 v48, 0
    v_mov_b32 v49, 0
    v_mov_b32 v50, 0
    v_mov_b32 v51, 0
    v_mov_b32 v52, 0
    v_mov_b32 v53, 0
    v_mov_b32 v54, 0
    v_mov_b32 v55, 0
    v_mov_b32 v56, 0
    v_mov_b32 v57, 0
    v_mov_b32 v58, 0
    v_mov_b32 v59, 0
    v_mov_b32 v60, 0
    v_mov_b32 v61, 0
    v_mov_b32 v62, 0
    v_mov_b32 v63, 0
Lpoll_31:
    buffer_load_dwordx4 v[92:95], v1, s[8:11], s70 offen sc1
    s_add_u32 s84, s84, 1
    s_cmp_gt_u32 s84, 400000
    s_waitcnt vmcnt(1)
    s_cbranch_scc1 Lpout_32
    v_max_u32 v31, v92, v93
    v_max3_u32 v31, v31, v94, v95
    v_cmp_eq_u32 vcc, -1, v31
    s_cbranch_vccnz Lpoll_31
Lpout_32:
    ds_write2_b32 v21, v92, v94 offset0:0 offset1:1
    ds_write2_b32 v21, v93, v95 offset0:40 offset1:41
    s_mov_b32 s80, 1
    s_add_u32 s8, s8, 0xc0000
    s_addc_u32 s9, s9, 0
    s_waitcnt lgkmcnt(0)
    s_barrier
    ds_read_b128 v[64:67], v23 offset:0
    ds_read_b128 v[68:71], v23 offset:64
    s_waitcnt lgkmcnt(1)
    v_smfmac_f32_16x16x64_bf16 v[32:35], v[64:67], a[0:7], v126
    s_waitcnt lgkmcnt(0)
    v_smfmac_f32_16x16x64_bf16 v[32:35], v[68:71], a[8:15], v126
    v_smfmac_f32_16x16x64_bf16 v[36:39], v[64:67], a[16:23], v126
    v_smfmac_f32_16x16x64_bf16 v[36:39], v[68:71], a[24:31], v126
    v_smfmac_f32_16x16x64_bf16 v[40:43], v[64:67], a[32:39], v126
    v_smfmac_f32_16x16x64_bf16 v[40:43], v[68:71], a[40:47], v126
    v_smfmac_f32_16x16x64_bf16 v[44:47], v[64:67], a[48:55], v126
    s_nop 2
    v_add_f32 v32, v32, v33
    v_add_f32 v34, v34, v35
    v_smfmac_f32_16x16x64_bf16 v[44:47], v[68:71], a[56:63], v126
    v_add_f32 v32, v32, v34
    v_smfmac_f32_16x16x64_bf16 v[48:51], v[64:67], a[64:71], v126
    v_add_f32 v36, v36, v37
    v_add_f32 v38, v38, v39
    v_smfmac_f32_16x16x64_bf16 v[48:51], v[68:71], a[72:79], v126
    v_add_f32 v36, v36, v38
    v_smfmac_f32_16x16x64_bf16 v[52:55], v[64:67], a[80:87], v126
    v_add_f32 v40, v40, v41
    v_add_f32 v42, v42, v43
    v_smfmac_f32_16x16x64_bf16 v[52:55], v[68:71], a[88:95], v126
    v_add_f32 v40, v40, v42
    v_smfmac_f32_16x16x64_bf16 v[56:59], v[64:67], a[96:103], v126
    v_add_f32 v44, v44, v45
    v_add_f32 v46, v46, v47
    v_smfmac_f32_16x16x64_bf16 v[56:59], v[68:71], a[104:111], v126
    v_add_f32 v44, v44, v46
    v_cndmask_b32 v24, v32, v40, s[78:79]
    v_smfmac_f32_16x16x64_bf16 v[60:63], v[64:67], a[112:119], v126
    v_cndmask_b32 v27, v36, v44, s[78:79]
    v_add_f32 v48, v48, v49
    v_smfmac_f32_16x16x64_bf16 v[60:63], v[68:71], a[120:127], v126
    v_add_f32 v50, v50, v51
    v_add_f32 v48, v48, v50
    v_add_f32 v52, v52, v53
    v_add_f32 v54, v54, v55
    v_add_f32 v52, v52, v54
    v_permlane16_swap_b32 v24, v27
    v_add_f32 v56, v56, v57
    v_add_f32 v58, v58, v59
    v_add_f32 v56, v56, v58
    v_add_f32 v24, v24, v27
    v_mul_f32 v24, s82, v24
    v_add_f32 v60, v60, v61
    v_add_f32 v62, v62, v63
    v_add_f32 v60, v60, v62
    v_cndmask_b32 v25, v48, v56, s[78:79]
    v_cndmask_b32 v28, v52, v60, s[78:79]
    v_mov_b32 v32, 0
    v_mov_b32 v33, 0
    v_permlane16_swap_b32 v25, v28
    v_add_f32 v25, v25, v28
    v_mul_f32 v25, s82, v25
    v_max_f32 v26, v24, v25
    v_mov_b32 v36, 0
    v_mov_b32 v37, 0
    v_max_f32_dpp v26, v26, v26 row_shr:1 row_mask:0xf bank_mask:0xf
    v_mov_b32 v40, 0
    v_mov_b32 v41, 0
    v_max_f32_dpp v26, v26, v26 row_shr:2 row_mask:0xf bank_mask:0xf
    v_mov_b32 v44, 0
    v_mov_b32 v45, 0
    v_max_f32_dpp v26, v26, v26 row_shr:4 row_mask:0xf bank_mask:0xf
    v_mov_b32 v48, 0
    v_mov_b32 v49, 0
    v_max_f32_dpp v26, v26, v26 row_shr:8 row_mask:0xf bank_mask:0xf
    v_mov_b32 v52, 0
    v_mov_b32 v53, 0
    v_max_f32_dpp v26, v26, v26 row_bcast:15 row_mask:0xa bank_mask:0xf
    v_mov_b32 v56, 0
    v_mov_b32 v57, 0
    v_max_f32_dpp v26, v26, v26 row_bcast:31 row_mask:0xc bank_mask:0xf
    v_mov_b32 v60, 0
    v_readlane_b32 s87, v26, 63
    v_mov_b32 v61, 0
    s_nop 0
    v_subrev_f32 v24, s87, v24
    v_subrev_f32 v25, s87, v25
    v_exp_f32 v24, v24
    v_exp_f32 v25, v25
    s_nop 0
    v_cvt_pk_bf16_f32 v26, v24, v25
    ds_write_b16 v123, v26
    ds_write_b16_d16_hi v123, v26 offset:64
    ds_read_b128 v[72:75], v124 offset:0
    ds_read_b128 v[76:79], v124 offset:64
    v_add_f32 v30, v24, v25
    v_mov_b32 v26, s87
    s_nop 0
    v_add_f32_dpp v30, v30, v30 row_shr:1 row_mask:0xf bank_mask:0xf
    s_nop 1
    v_add_f32_dpp v30, v30, v30 row_shr:2 row_mask:0xf bank_mask:0xf
    s_nop 1
    v_add_f32_dpp v30, v30, v30 row_shr:4 row_mask:0xf bank_mask:0xf
    s_nop 1
    v_add_f32_dpp v30, v30, v30 row_shr:8 row_mask:0xf bank_mask:0xf
    s_nop 1
    v_add_f32_dpp v30, v30, v30 row_bcast:15 row_mask:0xa bank_mask:0xf
    s_nop 1
    v_add_f32_dpp v30, v30, v30 row_bcast:31 row_mask:0xc bank_mask:0xf
    s_nop 0
    v_readlane_b32 s88, v30, 63
    s_waitcnt lgkmcnt(0)
    v_smfmac_f32_16x16x64_bf16 v[32:35], v[72:75], v[128:135], v126
    v_mov_b32 v27, s88
    v_smfmac_f32_16x16x64_bf16 v[32:35], v[76:79], v[136:143], v126
    ds_write2_b32 v8, v26, v27 offset0:0 offset1:4
    v_smfmac_f32_16x16x64_bf16 v[36:39], v[72:75], v[144:151], v126
    v_smfmac_f32_16x16x64_bf16 v[36:39], v[76:79], v[152:159], v126
    v_smfmac_f32_16x16x64_bf16 v[40:43], v[72:75], v[160:167], v126
    v_smfmac_f32_16x16x64_bf16 v[40:43], v[76:79], v[168:175], v126
    v_smfmac_f32_16x16x64_bf16 v[44:47], v[72:75], v[176:183], v126
    v_smfmac_f32_16x16x64_bf16 v[44:47], v[76:79], v[184:191], v126
    v_smfmac_f32_16x16x64_bf16 v[48:51], v[72:75], v[192:199], v126
    v_add_f32 v32, v32, v33
    v_smfmac_f32_16x16x64_bf16 v[48:51], v[76:79], v[200:207], v126
    v_smfmac_f32_16x16x64_bf16 v[52:55], v[72:75], v[208:215], v126
    v_add_f32 v36, v36, v37
    v_smfmac_f32_16x16x64_bf16 v[52:55], v[76:79], v[216:223], v126
    v_smfmac_f32_16x16x64_bf16 v[56:59], v[72:75], v[224:231], v126
    v_add_f32 v40, v40, v41
    v_smfmac_f32_16x16x64_bf16 v[56:59], v[76:79], v[232:239], v126
    v_smfmac_f32_16x16x64_bf16 v[60:63], v[72:75], v[240:247], v126
    v_add_f32 v44, v44, v45
    v_smfmac_f32_16x16x64_bf16 v[60:63], v[76:79], v[248:255], v126
    v_cndmask_b32 v24, v32, v36, s[72:73]
    v_cndmask_b32 v24, v24, v40, s[74:75]
    v_cndmask_b32 v24, v24, v44, s[76:77]
    v_add_f32 v48, v48, v49
    v_add_f32 v52, v52, v53
    v_add_f32 v56, v56, v57
    s_nop 1
    v_add_f32 v60, v60, v61
    v_cndmask_b32 v25, v48, v52, s[72:73]
    v_cndmask_b32 v25, v25, v56, s[74:75]
    v_cndmask_b32 v25, v25, v60, s[76:77]
    ds_write2st64_b32 v7, v24, v25 offset0:0 offset1:1
    s_waitcnt lgkmcnt(0)
    s_barrier
    s_branch L_loopB
L_last:
    s_add_u32 s88, s87, 4096
    s_waitcnt vmcnt(0)
Lpoll_33:
    buffer_load_dwordx4 v[112:115], v17, s[8:11], s87 offen sc1
    buffer_load_dwordx4 v[116:119], v17, s[8:11], s88 offen sc1
    s_add_u32 s84, s84, 1
    s_cmp_gt_u32 s84, 400000
    s_waitcnt vmcnt(0)
    s_cbranch_scc1 Lpout_34
    v_max_u32 v31, v112, v113
    v_max3_u32 v31, v31, v114, v115
    v_max3_u32 v31, v31, v116, v117
    v_max3_u32 v31, v31, v118, v119
    v_cmp_eq_u32 vcc, -1, v31
    s_cbranch_vccnz Lpoll_33
Lpout_34:
    v_add_f32 v64, v112, v116
    v_add_f32 v65, v113, v117
    v_add_f32 v66, v114, v118
    v_add_f32 v67, v115, v119
    v_add_f32_dpp v64, v64, v64 row_ror:8 row_mask:0xf bank_mask:0xf
    v_add_f32_dpp v65, v65, v65 row_ror:8 row_mask:0xf bank_mask:0xf
    v_add_f32_dpp v66, v66, v66 row_ror:8 row_mask:0xf bank_mask:0xf
    v_add_f32_dpp v67, v67, v67 row_ror:8 row_mask:0xf bank_mask:0xf
    v_add_f32_dpp v64, v64, v64 row_ror:4 row_mask:0xf bank_mask:0xf
    v_add_f32_dpp v65, v65, v65 row_ror:4 row_mask:0xf bank_mask:0xf
    v_add_f32_dpp v66, v66, v66 row_ror:4 row_mask:0xf bank_mask:0xf
    v_add_f32_dpp v67, v67, v67 row_ror:4 row_mask:0xf bank_mask:0xf
    v_add_f32_dpp v64, v64, v64 row_ror:2 row_mask:0xf bank_mask:0xf
    v_add_f32_dpp v65, v65, v65 row_ror:2 row_mask:0xf bank_mask:0xf
    v_add_f32_dpp v66, v66, v66 row_ror:2 row_mask:0xf bank_mask:0xf
    v_add_f32_dpp v67, v67, v67 row_ror:2 row_mask:0xf bank_mask:0xf
    v_add_f32_dpp v64, v64, v64 row_ror:1 row_mask:0xf bank_mask:0xf
    v_add_f32_dpp v65, v65, v65 row_ror:1 row_mask:0xf bank_mask:0xf
    v_add_f32_dpp v66, v66, v66 row_ror:1 row_mask:0xf bank_mask:0xf
    v_add_f32_dpp v67, v67, v67 row_ror:1 row_mask:0xf bank_mask:0xf
    v_add_f32 v64, v80, v64
    v_add_f32 v65, v81, v65
    v_add_f32 v66, v82, v66
    v_add_f32 v67, v83, v67
    v_cvt_pk_bf16_f32 v72, v64, v65
    v_cvt_pk_bf16_f32 v73, v66, v67
L_out:
    s_lshl_b32 s85, s5, 5
    v_add_u32 v26, s85, v20
    s_mov_b64 exec, s[92:93]
    global_store_dwordx2 v26, v[72:73], s[36:37]
    s_mov_b64 exec, -1
    s_cmp_lg_u32 s5, 0
    s_cbranch_scc1 L_endB
    v_mov_b32 v26, 0x190000
    v_mov_b32 v27, s56
    s_mov_b64 exec, 1
    global_store_dword v26, v27, s[40:41] sc1
    s_mov_b64 exec, -1
L_endB:
    s_endpgm
Lq_1:
    s_nop 7
    s_mov_b64 exec, 0x5555
    buffer_store_dwordx2 v[96:97], v125, s[8:11], s39 offen sc1
    s_mov_b64 exec, -1
Lq_2:
    s_sleep 8
    buffer_load_dwordx4 v[32:35], v1, s[8:11], s57 offen offset:0 sc1
    buffer_load_dwordx4 v[36:39], v1, s[8:11], s57 offen offset:1024 sc1
    s_add_u32 s84, s84, 1
    s_cmp_gt_u32 s84, 400000
    s_waitcnt vmcnt(0)
    s_cbranch_scc1 Lq_3
    v_xor_b32 v24, s56, v33
    v_xor_b32 v25, s56, v35
    v_xor_b32 v26, s56, v37
    v_xor_b32 v27, s56, v39
    v_or3_b32 v24, v24, v25, v26
    v_or_b32 v24, v24, v27
    v_cmp_lt_u32 vcc, 7, v24
    s_cbranch_vccnz Lq_2
    s_nop 7
    s_branch Lq_3
Lslow_4:
    s_nop 7
    buffer_store_dword v24, v11, s[8:11], s87 offen sc1
    s_nop 7
    s_branch Ljoin_5
Lslow_6:
    s_nop 7
    buffer_store_dwordx4 v[96:99], v1, s[8:11], s85 offen sc1
    s_nop 7
    s_branch Ljoin_7
Lq_12:
    s_nop 7
    s_mov_b64 exec, 0x5555
    buffer_store_dwordx2 v[96:97], v125, s[8:11], s39 offen sc1
    s_mov_b64 exec, -1
Lq_13:
    s_sleep 8
    buffer_load_dwordx4 v[32:35], v1, s[8:11], s57 offen offset:0 sc1
    buffer_load_dwordx4 v[36:39], v1, s[8:11], s57 offen offset:1024 sc1
    s_add_u32 s84, s84, 1
    s_cmp_gt_u32 s84, 400000
    s_waitcnt vmcnt(0)
    s_cbranch_scc1 Lq_14
    v_xor_b32 v24, s56, v33
    v_xor_b32 v25, s56, v35
    v_xor_b32 v26, s56, v37
    v_xor_b32 v27, s56, v39
    v_or3_b32 v24, v24, v25, v26
    v_or_b32 v24, v24, v27
    v_cmp_lt_u32 vcc, 7, v24
    s_cbranch_vccnz Lq_13
    s_nop 7
    s_branch Lq_14
L_gslow:
    s_nop 7
    s_mov_b64 exec, 1
    buffer_store_dword v97, v98, s[8:11], s43 offen sc1
    s_mov_b64 exec, -1
L_gs1:
    s_sleep 8
    buffer_load_dword v101, v99, s[8:11], s43 offen sc1
    s_add_u32 s84, s84, 1
    s_cmp_gt_u32 s84, 400000
    s_waitcnt vmcnt(0)
    s_cbranch_scc1 L_gdone
    v_xor_b32 v28, s56, v101
    v_cmp_lt_u32 vcc, 7, v28
    s_cbranch_vccnz L_gs1
    s_cmp_lg_u32 s5, 0
    s_cbranch_scc1 L_gs2
    s_add_u32 s85, s43, 0x1000
    s_mov_b64 exec, 1
    buffer_store_dword v97, v98, s[8:11], s85 offen sc1
    s_mov_b64 exec, -1
L_gs2:
    v_cmp_ne_u32 vcc, s56, v101
    s_cmp_eq_u64 vcc, 0
    s_cselect_b32 s81, 1, 0
    s_cbranch_scc1 L_gdone
    s_mul_i32 s85, s5, 2176
    s_add_u32 s85, s85, s38
    v_mov_b32 v104, -1
    v_mov_b32 v105, -1
    v_mov_b32 v106, -1
    v_mov_b32 v107, -1
    buffer_store_dwordx4 v[104:107], v1, s[8:11], s85 offen sc1
    buffer_store_dwordx4 v[104:107], v1, s[8:11], s85 offen offset:1024 sc1
    s_mov_b64 exec, 0xff
    buffer_store_dwordx4 v[104:107], v1, s[8:11], s85 offen offset:2048 sc1
    s_waitcnt vmcnt(0)
    s_mov_b64 exec, 1
    buffer_store_dword v97, v98, s[8:11], s43 offen offset:1024 sc1
    s_mov_b64 exec, -1
L_gs3:
    s_sleep 8
    buffer_load_dword v101, v99, s[8:11], s43 offen offset:1024 sc1
    s_add_u32 s84, s84, 1
    s_cmp_gt_u32 s84, 400000
    s_waitcnt vmcnt(0)
    s_cbranch_scc1 L_gdone
    v_xor_b32 v28, s56, v101
    v_cmp_lt_u32 vcc, 7, v28
    s_cbranch_vccnz L_gs3
    s_nop 7
    s_branch L_gdone
Lslow_15:
    s_nop 7
    buffer_store_dword v25, v19, s[8:11], s60 offen sc1
    s_mov_b64 exec, 3
    buffer_store_dword v24, v30, s[8:11], s61 offen sc1
    s_mov_b64 exec, -1
    s_nop 7
    s_branch Ljoin_16
L_fslow:
    s_nop 7
L_fs1:
    s_sleep 16
    buffer_load_dword v90, v89, s[8:11], 0 offen sc1
    s_add_u32 s84, s84, 1
    s_cmp_gt_u32 s84, 400000
    s_waitcnt vmcnt(0)
    s_cbranch_scc1 L_fdone
    v_xor_b32 v28, s56, v90
    v_cmp_lt_u32 vcc, 7, v28
    s_cbranch_vccnz L_fs1
    s_nop 7
    s_branch L_fdone
Lslow_21:
    s_nop 7
    v_mfma_f32_16x16x32_bf16 v[40:43], v[64:67], a[200:203], 0
    v_mfma_f32_16x16x32_bf16 v[44:47], v[64:67], a[204:207], 0
    v_mfma_f32_16x16x32_bf16 v[48:51], v[64:67], a[208:211], 0
    v_mfma_f32_16x16x32_bf16 v[52:55], v[64:67], a[212:215], 0
    v_cndmask_b32 v24, v32, v33, s[72:73]
    v_cndmask_b32 v24, v24, v36, s[74:75]
    v_cndmask_b32 v24, v24, v37, s[76:77]
    v_min_u32 v24, -2, v24
    buffer_store_dword v24, v11, s[8:11], s90 offen sc1
    v_min_u32 v27, -2, v76
    s_mov_b64 exec, 0xffffff
    buffer_store_dword v27, v88, s[8:11], s57 offen offset:1024 sc1
    s_mov_b64 exec, -1
    v_cndmask_b32 v25, v40, v41, s[72:73]
    v_cndmask_b32 v25, v25, v44, s[74:75]
    v_cndmask_b32 v25, v25, v45, s[76:77]
    v_min_u32 v25, -2, v25
    buffer_store_dword v25, v11, s[8:11], s85 offen sc1
    v_cndmask_b32 v26, v48, v49, s[72:73]
    v_cndmask_b32 v26, v26, v52, s[74:75]
    v_cndmask_b32 v26, v26, v53, s[76:77]
    v_min_u32 v26, -2, v26
    buffer_store_dword v26, v11, s[8:11], s86 offen sc1
    s_nop 7
    s_branch Ljoin_22
Lslow_25:
    s_nop 7
    buffer_store_dwordx2 v[74:75], v20, s[8:11], s66 offen offset:0 sc1
    s_nop 7
    s_branch Ljoin_26
Lslow_29:
    s_nop 7
    buffer_store_dword v25, v10, s[8:11], s68 offen sc1
    s_nop 7
    s_branch Ljoin_30
L_codeend:
L_end:
s_endpgm
.section .rodata,"a"
.p2align 6
.amdhsa_kernel interleave_layers__mha_block_cached__dense_activation_gelu__decode_kernel
  .amdhsa_next_free_vgpr 512
  .amdhsa_next_free_sgpr 102
  .amdhsa_accum_offset 256
  .amdhsa_group_segment_fixed_size 0
  .amdhsa_kernarg_size 104
  .amdhsa_user_sgpr_count 2
  .amdhsa_user_sgpr_kernarg_segment_ptr 1
  .amdhsa_system_sgpr_workgroup_id_x 1
  .amdhsa_float_denorm_mode_32 3
.end_amdhsa_kernel
```
